```python
import torch

def _softmax(x, axis=-1):
    return torch.softmax(x, dim=axis)
def _gelu(x):
    return torch.nn.functional.gelu(x, approximate="tanh")
def _silu(x):
    return torch.nn.functional.silu(x)
def _sigmoid(x):
    return torch.sigmoid(x)
def _layernorm(x, axis=-1, eps=1e-5):
    m = x.mean(dim=axis, keepdim=True)
    v = x.var(dim=axis, keepdim=True, unbiased=False)
    return (x - m) / torch.sqrt(v + eps)
def _scatter_add(tgt, idx, src, axis=0):
    return tgt.clone().index_add_(axis, idx, src)
def _segment_sum(src, seg, n):
    out = torch.zeros((n,) + src.shape[1:], dtype=src.dtype)
    return out.index_add_(0, seg, src)
def _pad(x, pw):
    flat = tuple(v for pair in reversed(pw) for v in pair)
    return torch.nn.functional.pad(x, flat)

kernel_name = 'concat_heads__ssm_conv_s4__linear_attn_block__prompt'

def setup_inputs():

    _w = (lambda a: (lambda t: t.to(torch.bfloat16) if t.is_floating_point() else t)(torch.as_tensor(a)))
    def _A_setup():
        B, L, D, N = 1, 2048, 576, 128
        A_re = -(lambda _x: torch.exp(torch.as_tensor(_x)))((lambda *s: torch.randn(*s, dtype=torch.bfloat16) * 6.4)(D, N))
        A_im = torch.pi * (lambda *s: torch.randn(*s, dtype=torch.bfloat16) * 0.05)(D, N)
        B_re = (lambda *s: torch.randn(*s, dtype=torch.bfloat16) * 0.1)(D, N)
        B_im = (lambda *s: torch.randn(*s, dtype=torch.bfloat16) * 0.1)(D, N)
        C_re = (lambda *s: torch.randn(*s, dtype=torch.bfloat16) * 0.1)(D, N)
        C_im = (lambda *s: torch.randn(*s, dtype=torch.bfloat16) * 0.1)(D, N)
        log_dt = (lambda *s: torch.randn(*s, dtype=torch.bfloat16) * 0.05)(D) * 0.5 - 4.0
        Dskip = (lambda *s: torch.randn(*s, dtype=torch.bfloat16) * 0.05)(D)
        return {
            "u": _w((lambda *s: torch.randn(*s, dtype=torch.bfloat16) * 0.05)(B, L, D)),
            "A_re": _w(A_re),
            "A_im": _w(A_im),
            "B_re": _w(B_re),
            "B_im": _w(B_im),
            "C_re": _w(C_re),
            "C_im": _w(C_im),
            "log_dt": _w(log_dt),
            "Dskip": _w(Dskip),
        }
    _A_in = _A_setup()

    def _B_setup():
        B, S, D = 1, 2048, 576
        return {
            "x": _w((lambda *s: torch.randn(*s, dtype=torch.bfloat16) * 0.05)(B, S, D)),
            "wqkv": _w((lambda *s: torch.randn(*s, dtype=torch.bfloat16) * 0.4)(D, 3 * D)),
            "wo": _w((lambda *s: torch.randn(*s, dtype=torch.bfloat16) * 0.05)(D, D)),
        }
    _B_in = _B_setup()

    return {
        "A_u": _A_in["u"],
        "A_A_re": _A_in["A_re"],
        "A_A_im": _A_in["A_im"],
        "A_B_re": _A_in["B_re"],
        "A_B_im": _A_in["B_im"],
        "A_C_re": _A_in["C_re"],
        "A_C_im": _A_in["C_im"],
        "A_log_dt": _A_in["log_dt"],
        "A_Dskip": _A_in["Dskip"],
        "B_x": _B_in["x"],
        "B_wqkv": _B_in["wqkv"],
        "B_wo": _B_in["wo"],
    }

def reference(A_u, A_A_re, A_A_im, A_B_re, A_B_im, A_C_re, A_C_im, A_log_dt, A_Dskip, B_x, B_wqkv, B_wo):
    def _A_ref(u, A_re, A_im, B_re, B_im, C_re, C_im, log_dt, Dskip):
        Bsz, L, D = u.shape
        dt = torch.exp(log_dt)[:, None]
        A = A_re + 1j * A_im
        Bc = B_re + 1j * B_im
        Cc = C_re + 1j * C_im
        logdA = dt * A
        dB = dt * Bc
        l = (lambda x, dt: x.to(dt))(torch.arange(L), A_re.dtype)
        P = torch.exp(logdA[:, :, None] * l[None, None, :])
        K = torch.einsum("dn,dnl,dn->dl", Cc, P, dB).real
        L2 = 2 * L
        Kp = _pad(K, ((0, 0), (0, L)))
        up = (lambda x, *d: x.permute(*d))(u, 0, 2, 1)
        up = _pad(up, ((0, 0), (0, 0), (0, L)))
        Kf = (lambda x, axes=(-2,-1): torch.fft.rfft2(x.float(), dim=axes))(Kp[:, None, :], axes=(-2, -1))
        Uf = (lambda x, axes=(-2,-1): torch.fft.rfft2(x.float(), dim=axes))(up[:, :, None, :], axes=(-2, -1))
        Yf = Uf * Kf[None, :, :, :]
        y = (lambda x, s, axes=(-2,-1): torch.fft.irfft2(x, s=s, dim=axes).to(torch.bfloat16))(Yf, (1, L2), axes=(-2, -1))[:, :, 0, :L]
        y = (lambda x, *d: x.permute(*d))(y, 0, 2, 1) + u * Dskip[None, None, :]
        return y

    def _B_ref(x, wqkv, wo):
        B, S, D = x.shape
        H = 32; Dh = D // H
        qkv = (lambda x, *d: x.permute(*d))((x @ wqkv).reshape(B, S, 3, H, Dh), 2, 0, 3, 1, 4)
        q, k, v = qkv[0], qkv[1], qkv[2]
        phi = lambda t: torch.where(t > 0, t + 1, torch.exp(t)) + 1e-6
        pq, pk = phi(q), phi(k)
        kv = torch.einsum("bhsd,bhse->bhde", pk, v)
        z = torch.einsum("bhsd->bhd", pk)
        num = torch.einsum("bhqd,bhde->bhqe", pq, kv)
        den = torch.einsum("bhqd,bhd->bhq", pq, z)[..., None] + 1e-6
        o = num / den
        return (lambda x, *d: x.permute(*d))(o, 0, 2, 1, 3).reshape(B, S, D) @ wo

    a = _A_ref(A_u, A_A_re, A_A_im, A_B_re, A_B_im, A_C_re, A_C_im, A_log_dt, A_Dskip)
    b = _B_ref(B_x, B_wqkv, B_wo)
    return torch.concatenate([a, b], axis=-1)
```

```asm
; @launch grid=(256,1,1) block=(512,1,1) lds=163840
.amdgcn_target "amdgcn-amd-amdhsa--gfx950"
.text
.globl concat_heads__ssm_conv_s4__linear_attn_block__prompt_kernel
.p2align 8
.type concat_heads__ssm_conv_s4__linear_attn_block__prompt_kernel,@function
concat_heads__ssm_conv_s4__linear_attn_block__prompt_kernel:
    s_load_dwordx16 s[4:19], s[0:1], 0
    s_load_dwordx8 s[44:51], s[0:1], 64
    s_load_dwordx4 s[52:55], s[0:1], 96
    s_load_dwordx2 s[56:57], s[0:1], 112
    s_cmp_ge_u32 s2, 128
    s_cbranch_scc1 L_roleA
    v_lshrrev_b32 v2, 6, v0
    v_and_b32 v1, 63, v0
    v_readfirstlane_b32 s24, v2
    s_and_b32 s32, s2, 7
    s_lshr_b32 s33, s2, 3
    s_and_b32 s34, s33, 3
    s_lshr_b32 s33, s33, 2
    s_lshr_b32 s25, s32, 1
    s_lshl_b32 s25, s25, 2
    s_add_u32 s25, s25, s34
    s_and_b32 s26, s32, 1
    s_lshl_b32 s26, s26, 2
    s_add_u32 s26, s26, s33
    s_mov_b32 s27, 0
    v_and_b32 v2, 15, v1
    v_lshrrev_b32 v3, 4, v1
    s_cmp_lt_u32 s24, 4
    s_cbranch_scc1 L_b_compute
    s_setprio 2
    s_sub_u32 s39, s24, 4
    v_lshrrev_b32 v4, 3, v1
    v_and_b32 v5, 7, v1
    v_xor_b32 v5, v5, v4
    s_lshl_b32 s32, s25, 7
    s_lshl_b32 s33, s39, 5
    s_add_u32 s32, s32, s33
    v_add_u32 v4, s32, v4
    v_mul_u32_u24 v4, 1152, v4
    v_lshl_add_u32 v8, v5, 4, v4
    s_lshr_b32 s32, s39, 1
    s_lshl_b32 s32, s32, 5
    s_and_b32 s33, s39, 1
    s_lshl_b32 s33, s33, 2
    s_add_u32 s32, s32, s33
    s_mul_i32 s40, s26, 144
    s_mul_i32 s32, s32, 3456
    s_add_u32 s32, s32, s40
    s_add_u32 s32, s32, 1152
    s_lshl_b32 s41, s39, 12
    s_mul_i32 s42, s39, 4608
    s_add_u32 s42, s42, 16384
    s_mov_b32 s43, s27
    s_mov_b32 s22, 1990656
    s_mov_b32 s23, 0x20000
    s_mov_b32 s30, 663552
    s_mov_b32 s31, 0x20000
    s_waitcnt lgkmcnt(0)
    s_mov_b64 s[16:17], s[46:47]
    s_mov_b32 s18, 2359296
    s_mov_b32 s19, 0x20000
    s_mov_b64 s[20:21], s[48:49]
    s_mov_b64 s[28:29], s[50:51]
    s_mov_b64 s[12:13], s[54:55]
    s_mov_b64 s[14:15], s[56:57]
    s_lshl_b32 s3, s43, 7
    s_mul_i32 s35, s43, 221184
    s_add_u32 m0, s41, 0
    s_nop 0
    buffer_load_dwordx4 v8, s[16:19], s3 offen lds
    s_add_u32 m0, s41, 1024
    s_add_u32 s3, s3, 9216
    buffer_load_dwordx4 v8, s[16:19], s3 offen lds
    s_add_u32 m0, s41, 2048
    s_add_u32 s3, s3, 9216
    buffer_load_dwordx4 v8, s[16:19], s3 offen lds
    s_add_u32 m0, s41, 3072
    s_add_u32 s3, s3, 9216
    buffer_load_dwordx4 v8, s[16:19], s3 offen lds
    v_add_u32 v4, 0, v1
    v_mul_u32_u24 v5, 3641, v4
    v_lshrrev_b32 v5, 16, v5
    v_mul_u32_u24 v7, 18, v5
    v_sub_u32 v6, v4, v7
    v_and_b32 v4, 12, v5
    v_add_u32 v4, v4, v5
    v_mul_u32_u24 v4, 3456, v4
    v_cmp_lt_u32 vcc, 8, v6
    v_lshl_add_u32 v4, v6, 4, v4
    v_add_u32 v4, s32, v4
    v_add_u32 v5, 1008, v4
    v_cndmask_b32 v9, v4, v5, vcc
    s_add_u32 m0, s42, 0
    s_nop 0
    buffer_load_dwordx4 v9, s[20:23], s35 offen lds
    v_add_u32 v4, 64, v1
    v_mul_u32_u24 v5, 3641, v4
    v_lshrrev_b32 v5, 16, v5
    v_mul_u32_u24 v7, 18, v5
    v_sub_u32 v6, v4, v7
    v_and_b32 v4, 12, v5
    v_add_u32 v4, v4, v5
    v_mul_u32_u24 v4, 3456, v4
    v_cmp_lt_u32 vcc, 8, v6
    v_lshl_add_u32 v4, v6, 4, v4
    v_add_u32 v4, s32, v4
    v_add_u32 v5, 1008, v4
    v_cndmask_b32 v10, v4, v5, vcc
    s_add_u32 m0, s42, 1024
    s_nop 0
    buffer_load_dwordx4 v10, s[20:23], s35 offen lds
    v_add_u32 v4, 128, v1
    v_mul_u32_u24 v5, 3641, v4
    v_lshrrev_b32 v5, 16, v5
    v_mul_u32_u24 v7, 18, v5
    v_sub_u32 v6, v4, v7
    v_and_b32 v4, 12, v5
    v_add_u32 v4, v4, v5
    v_mul_u32_u24 v4, 3456, v4
    v_cmp_lt_u32 vcc, 8, v6
    v_lshl_add_u32 v4, v6, 4, v4
    v_add_u32 v4, s32, v4
    v_add_u32 v5, 1008, v4
    v_cndmask_b32 v11, v4, v5, vcc
    s_add_u32 m0, s42, 2048
    s_nop 0
    buffer_load_dwordx4 v11, s[20:23], s35 offen lds
    v_add_u32 v4, 192, v1
    v_mul_u32_u24 v5, 3641, v4
    v_lshrrev_b32 v5, 16, v5
    v_mul_u32_u24 v7, 18, v5
    v_sub_u32 v6, v4, v7
    v_and_b32 v4, 12, v5
    v_add_u32 v4, v4, v5
    v_mul_u32_u24 v4, 3456, v4
    v_cmp_lt_u32 vcc, 8, v6
    v_lshl_add_u32 v4, v6, 4, v4
    v_add_u32 v4, s32, v4
    v_add_u32 v5, 1008, v4
    v_cndmask_b32 v12, v4, v5, vcc
    s_add_u32 m0, s42, 3072
    s_nop 0
    buffer_load_dwordx4 v12, s[20:23], s35 offen lds
    v_add_u32 v4, 256, v1
    v_mul_u32_u24 v5, 3641, v4
    v_lshrrev_b32 v5, 16, v5
    v_mul_u32_u24 v7, 18, v5
    v_sub_u32 v6, v4, v7
    v_and_b32 v4, 12, v5
    v_add_u32 v4, v4, v5
    v_mul_u32_u24 v4, 3456, v4
    v_cmp_lt_u32 vcc, 8, v6
    v_lshl_add_u32 v4, v6, 4, v4
    v_add_u32 v4, s32, v4
    v_add_u32 v5, 1008, v4
    v_cndmask_b32 v13, v4, v5, vcc
    s_add_u32 m0, s42, 4096
    s_mov_b32 exec_hi, 0
    buffer_load_dwordx4 v13, s[20:23], s35 offen lds
    s_mov_b32 exec_hi, -1
    s_add_u32 s43, s43, 1
    s_cmp_eq_u32 s43, 9
    s_cselect_b32 s43, 0, s43
    s_branch L_sec_loader
L_roleA:
    s_cmp_ge_u32 s2, 256
    s_cbranch_scc1 L_exit
    s_sub_u32 s24, s2, 128
    s_and_b32 s25, s24, 7
    s_lshr_b32 s24, s24, 3
    s_lshr_b32 s27, s24, 2
    s_lshl_b32 s27, s27, 3
    s_add_u32 s27, s27, s25
    s_cmp_ge_u32 s27, 18
    s_nop 0
    s_cbranch_scc1 L_roleH
    s_mov_b32 s41, s24
    s_mov_b32 s42, s25
    s_and_b32 s26, s24, 3
    s_lshl_b32 s27, s25, 2
    s_add_u32 s27, s27, 56
    s_lshl_b32 s25, s25, 3
    s_cmp_lt_u32 s24, 8
    s_cselect_b32 s25, s25, s27
    s_add_u32 s25, s25, s24
    v_lshrrev_b32 v10, 6, v0
    v_and_b32 v1, 63, v0
    v_readfirstlane_b32 s24, v10
    s_mov_b32 s30, 0x05040100
    s_mov_b32 s31, 0x07060302
    s_lshl_b32 s28, s25, 3
    s_add_u32 s28, s28, s24
    s_lshl_b32 s29, s28, 8
    v_lshl_add_u32 v10, v1, 2, s29
    s_lshl_b32 s29, s28, 1
    v_mov_b32 v11, s29
    v_lshlrev_b32 v12, 2, v0
    v_mul_u32_u24 v13, 1152, v12
    s_lshl_b32 s29, s25, 4
    v_add_u32 v13, s29, v13
    v_mul_u32_u24 v14, 4608, v0
    v_add_u32 v14, s29, v14
    s_mul_i32 s27, s24, 8960
    s_add_u32 s27, s27, 64
    s_mov_b32 m0, s27
    s_waitcnt lgkmcnt(0)
    global_load_ushort v8, v11, s[18:19]
    global_load_dword v2, v10, s[6:7]
    global_load_dword v3, v10, s[8:9]
    global_load_dword v4, v10, s[10:11]
    global_load_dword v5, v10, s[12:13]
    global_load_dword v6, v10, s[14:15]
    global_load_dword v7, v10, s[16:17]
    global_load_ushort v9, v11, s[44:45]
    s_and_b32 s39, s41, 3
    s_add_u32 s39, s39, 1
    s_lshr_b32 s40, s41, 2
    s_mul_i32 s40, s40, 288
    v_min_u32 v36, 287, v0
    v_add_u32 v36, s40, v36
    s_lshr_b32 s36, s42, 1
    s_mul_i32 s36, s36, 589824
    s_lshl_b32 s37, s39, 7
    s_add_u32 s36, s36, s37
    s_and_b32 s37, s42, 1
    s_lshl_b32 s37, s37, 9
    s_mul_i32 s38, s39, 221184
    s_add_u32 s37, s37, s38
    s_add_u32 s37, s37, 1152
    v_cmp_gt_u32 vcc, 512, v36
    v_mul_u32_u24 v37, 1152, v36
    v_add_u32 v37, s36, v37
    v_subrev_u32 v36, 512, v36
    v_max_i32 v36, 0, v36
    v_mul_u32_u24 v38, 13108, v36
    v_lshrrev_b32 v38, 16, v38
    v_mul_u32_u24 v40, 5, v38
    v_sub_u32 v39, v36, v40
    v_and_b32 v36, 1, v38
    v_lshrrev_b32 v38, 1, v38
    v_mul_u32_u24 v38, 3456, v38
    v_mul_u32_u24 v36, 1152, v36
    v_lshl_add_u32 v39, v39, 7, s37
    v_add3_u32 v38, v38, v36, v39
    v_mov_b32 v36, s46
    v_mov_b32 v39, s48
    v_cndmask_b32 v37, v38, v37, vcc
    v_cndmask_b32 v38, v39, v36, vcc
    v_mov_b32 v36, s47
    v_mov_b32 v39, s49
    v_cndmask_b32 v39, v39, v36, vcc
    v_add_co_u32 v38, vcc, v38, v37
    s_nop 1
    v_addc_co_u32 v39, vcc, 0, v39, vcc
    global_load_dword v10, v[38:39], off
    s_lshr_b32 s39, s41, 2
    s_add_u32 s39, s39, 5
    s_and_b32 s40, s41, 3
    s_mul_i32 s40, s40, 288
    v_min_u32 v36, 287, v0
    v_add_u32 v36, s40, v36
    s_lshr_b32 s36, s42, 1
    s_mul_i32 s36, s36, 589824
    s_lshl_b32 s37, s39, 7
    s_add_u32 s36, s36, s37
    s_and_b32 s37, s42, 1
    s_lshl_b32 s37, s37, 9
    s_mul_i32 s38, s39, 221184
    s_add_u32 s37, s37, s38
    s_add_u32 s37, s37, 1152
    v_cmp_gt_u32 vcc, 512, v36
    v_mul_u32_u24 v37, 1152, v36
    v_add_u32 v37, s36, v37
    v_subrev_u32 v36, 512, v36
    v_max_i32 v36, 0, v36
    v_mul_u32_u24 v38, 13108, v36
    v_lshrrev_b32 v38, 16, v38
    v_mul_u32_u24 v40, 5, v38
    v_sub_u32 v39, v36, v40
    v_and_b32 v36, 1, v38
    v_lshrrev_b32 v38, 1, v38
    v_mul_u32_u24 v38, 3456, v38
    v_mul_u32_u24 v36, 1152, v36
    v_lshl_add_u32 v39, v39, 7, s37
    v_add3_u32 v38, v38, v36, v39
    v_mov_b32 v36, s46
    v_mov_b32 v39, s48
    v_cndmask_b32 v37, v38, v37, vcc
    v_cndmask_b32 v38, v39, v36, vcc
    v_mov_b32 v36, s47
    v_mov_b32 v39, s49
    v_cndmask_b32 v39, v39, v36, vcc
    v_add_co_u32 v38, vcc, v38, v37
    s_nop 1
    v_addc_co_u32 v39, vcc, 0, v39, vcc
    global_load_dword v11, v[38:39], off
    s_cmp_lt_u32 s24, 4
    s_cbranch_scc1 L_a_pr1
    s_setprio 1
L_a_pr1:
    s_branch L_sec_amain
L_roleH:
    s_getpc_b64 s[32:33]
L_h_pc:
    s_sub_u32 s32, s32, L_h_pc-concat_heads__ssm_conv_s4__linear_attn_block__prompt_kernel
    s_subb_u32 s33, s33, 0
    v_lshlrev_b32 v1, 7, v0
    v_cmp_gt_u32 vcc, L_end-concat_heads__ssm_conv_s4__linear_attn_block__prompt_kernel, v1
    s_nop 0
    s_and_saveexec_b64 s[34:35], vcc
    s_cbranch_execz L_h_nocode
    global_load_dword v2, v1, s[32:33]
L_h_nocode:
    s_mov_b64 exec, s[34:35]
    s_mov_b32 s41, s24
    s_mov_b32 s42, s25
    s_sub_u32 s26, s2, 224
    s_sub_u32 s27, s24, 8
    s_mul_i32 s27, s27, 6
    s_add_u32 s27, s27, s25
    s_add_u32 s27, s27, 30
    s_cmp_ge_u32 s24, 12
    s_cselect_b32 s26, s26, s27
    s_lshl_b32 s27, s26, 13
    v_lshl_add_u32 v3, v0, 4, s27
    s_mul_i32 s27, s26, 49152
    s_add_u32 s27, s27, 393216
    v_lshl_add_u32 v4, v0, 4, s27
    s_and_b32 s27, s26, 3
    s_lshl_b32 s27, s27, 6
    v_mov_b32 v30, s27
    v_mov_b32 v31, 1
    v_mov_b32 v8, -1
    v_mov_b32 v9, -1
    v_mov_b32 v10, -1
    v_mov_b32 v11, -1
    s_and_b32 s24, s24, 3
    s_mul_i32 s24, s24, 144
    s_and_b32 s25, s25, 1
    s_lshl_b32 s25, s25, 9
    v_add_u32 v16, 0, v0
    v_min_u32 v16, 719, v16
    v_mul_u32_u24 v5, 13108, v16
    v_lshrrev_b32 v5, 16, v5
    v_mul_u32_u24 v7, 5, v5
    v_sub_u32 v6, v16, v7
    v_add_u32 v5, s24, v5
    v_lshl_add_u32 v6, v6, 7, s25
    v_mul_u32_u24 v7, 3456, v5
    v_mul_u32_u24 v5, 1152, v5
    v_add_u32 v14, v7, v6
    v_add_u32 v12, v5, v6
    v_add_u32 v16, 512, v0
    v_min_u32 v16, 719, v16
    v_mul_u32_u24 v5, 13108, v16
    v_lshrrev_b32 v5, 16, v5
    v_mul_u32_u24 v7, 5, v5
    v_sub_u32 v6, v16, v7
    v_add_u32 v5, s24, v5
    v_lshl_add_u32 v6, v6, 7, s25
    v_mul_u32_u24 v7, 3456, v5
    v_mul_u32_u24 v5, 1152, v5
    v_add_u32 v15, v7, v6
    v_add_u32 v13, v5, v6
    s_waitcnt lgkmcnt(0)
    s_and_b32 s39, s41, 3
    s_add_u32 s39, s39, 1
    s_lshr_b32 s40, s41, 2
    s_mul_i32 s40, s40, 288
    v_min_u32 v24, 287, v0
    v_add_u32 v24, s40, v24
    s_lshr_b32 s36, s42, 1
    s_mul_i32 s36, s36, 589824
    s_lshl_b32 s37, s39, 7
    s_add_u32 s36, s36, s37
    s_and_b32 s37, s42, 1
    s_lshl_b32 s37, s37, 9
    s_mul_i32 s38, s39, 221184
    s_add_u32 s37, s37, s38
    s_add_u32 s37, s37, 1152
    v_cmp_gt_u32 vcc, 512, v24
    v_mul_u32_u24 v25, 1152, v24
    v_add_u32 v25, s36, v25
    v_subrev_u32 v24, 512, v24
    v_max_i32 v24, 0, v24
    v_mul_u32_u24 v26, 13108, v24
    v_lshrrev_b32 v26, 16, v26
    v_mul_u32_u24 v28, 5, v26
    v_sub_u32 v27, v24, v28
    v_and_b32 v24, 1, v26
    v_lshrrev_b32 v26, 1, v26
    v_mul_u32_u24 v26, 3456, v26
    v_mul_u32_u24 v24, 1152, v24
    v_lshl_add_u32 v27, v27, 7, s37
    v_add3_u32 v26, v26, v24, v27
    v_mov_b32 v24, s46
    v_mov_b32 v27, s48
    v_cndmask_b32 v25, v26, v25, vcc
    v_cndmask_b32 v26, v27, v24, vcc
    v_mov_b32 v24, s47
    v_mov_b32 v27, s49
    v_cndmask_b32 v27, v27, v24, vcc
    v_add_co_u32 v26, vcc, v26, v25
    s_nop 1
    v_addc_co_u32 v27, vcc, 0, v27, vcc
    global_load_dword v20, v[26:27], off
    s_waitcnt vmcnt(0)
    s_lshr_b32 s39, s41, 2
    s_add_u32 s39, s39, 5
    s_and_b32 s40, s41, 3
    s_mul_i32 s40, s40, 288
    v_min_u32 v24, 287, v0
    v_add_u32 v24, s40, v24
    s_lshr_b32 s36, s42, 1
    s_mul_i32 s36, s36, 589824
    s_lshl_b32 s37, s39, 7
    s_add_u32 s36, s36, s37
    s_and_b32 s37, s42, 1
    s_lshl_b32 s37, s37, 9
    s_mul_i32 s38, s39, 221184
    s_add_u32 s37, s37, s38
    s_add_u32 s37, s37, 1152
    v_cmp_gt_u32 vcc, 512, v24
    v_mul_u32_u24 v25, 1152, v24
    v_add_u32 v25, s36, v25
    v_subrev_u32 v24, 512, v24
    v_max_i32 v24, 0, v24
    v_mul_u32_u24 v26, 13108, v24
    v_lshrrev_b32 v26, 16, v26
    v_mul_u32_u24 v28, 5, v26
    v_sub_u32 v27, v24, v28
    v_and_b32 v24, 1, v26
    v_lshrrev_b32 v26, 1, v26
    v_mul_u32_u24 v26, 3456, v26
    v_mul_u32_u24 v24, 1152, v24
    v_lshl_add_u32 v27, v27, 7, s37
    v_add3_u32 v26, v26, v24, v27
    v_mov_b32 v24, s46
    v_mov_b32 v27, s48
    v_cndmask_b32 v25, v26, v25, vcc
    v_cndmask_b32 v26, v27, v24, vcc
    v_mov_b32 v24, s47
    v_mov_b32 v27, s49
    v_cndmask_b32 v27, v27, v24, vcc
    v_add_co_u32 v26, vcc, v26, v25
    s_nop 1
    v_addc_co_u32 v27, vcc, 0, v27, vcc
    global_load_dword v21, v[26:27], off
    s_cmp_lt_u32 s41, 12
    s_nop 0
    s_cbranch_scc1 L_h_noq
    global_load_dword v16, v14, s[48:49]
    global_load_dword v17, v15, s[48:49]
L_h_noq:
    s_cmp_ge_u32 s26, 48
    s_nop 0
    s_cbranch_scc1 L_h_nok
    global_store_dwordx4 v3, v[8:11], s[56:57] sc1
L_h_nok:
    s_waitcnt vmcnt(0)
    s_barrier
    s_cmp_ge_u32 s26, 48
    s_cbranch_scc1 L_h_noK
    v_cmp_eq_u32 vcc, 0, v0
    s_nop 0
    s_and_saveexec_b64 s[34:35], vcc
    s_cbranch_execz L_h_reK
    global_atomic_add v30, v31, s[54:55] offset:0 sc1
L_h_reK:
    s_mov_b64 exec, s[34:35]
L_h_noK:
    s_cmp_lt_u32 s41, 12
    s_nop 0
    s_cbranch_scc1 L_h_noo
    global_load_dword v18, v12, s[50:51]
    global_load_dword v19, v13, s[50:51]
L_h_noo:
    s_waitcnt vmcnt(0)
    s_cmp_ge_u32 s26, 48
    s_nop 0
    s_cbranch_scc1 L_h_noc
    global_store_dwordx4 v4, v[8:11], s[56:57] sc1
    v_add_u32 v4, 8192, v4
    global_store_dwordx4 v4, v[8:11], s[56:57] sc1
    v_add_u32 v4, 8192, v4
    global_store_dwordx4 v4, v[8:11], s[56:57] sc1
    v_add_u32 v4, 8192, v4
    global_store_dwordx4 v4, v[8:11], s[56:57] sc1
    v_add_u32 v4, 8192, v4
    global_store_dwordx4 v4, v[8:11], s[56:57] sc1
    v_add_u32 v4, 8192, v4
    global_store_dwordx4 v4, v[8:11], s[56:57] sc1
L_h_noc:
    s_waitcnt vmcnt(0)
    s_barrier
    s_cmp_ge_u32 s26, 48
    s_cbranch_scc1 L_h_noC
    v_cmp_eq_u32 vcc, 0, v0
    s_nop 0
    s_and_saveexec_b64 s[34:35], vcc
    s_cbranch_execz L_h_reC
    global_atomic_add v30, v31, s[54:55] offset:4 sc1
L_h_reC:
    s_mov_b64 exec, s[34:35]
L_h_noC:
    s_cmp_lt_u32 s41, 12
    s_cbranch_scc1 L_exit
    s_endpgm
L_exit:
    s_endpgm
L_b_compute:
    s_mov_b32 s39, s24
    s_mul_i32 s40, s26, 144
    s_waitcnt lgkmcnt(0)
    s_lshl_b32 s32, s26, 2
    s_add_u32 s32, s32, s39
    s_mul_i32 s32, s32, 12288
    s_add_u32 s32, s32, 0
    v_lshl_add_u32 v15, v1, 4, s32
    s_lshl_b32 s33, s25, 8
    s_add_u32 s32, s32, s33
    v_lshlrev_b32 v14, 4, v2
    v_lshl_add_u32 v14, v3, 12, v14
    v_add_u32 v14, s32, v14
    s_mul_i32 s32, s39, 2304
    s_add_u32 s32, s32, 153088
    v_lshl_add_u32 v4, v1, 4, s32
    v_mov_b32 v40, 0
    v_mov_b32 v41, 0
    v_mov_b32 v42, 0
    v_mov_b32 v43, 0
    ds_write_b128 v4, v[40:43]
    ds_write_b128 v4, v[40:43] offset:1024
    v_lshl_add_u32 v4, v1, 2, s32
    ds_write_b32 v4, v40 offset:2048
    v_mov_b32 v55, 162304
    ds_write_b32 v55, v40
    s_lshr_b32 s45, s39, 1
    s_lshl_b32 s46, s39, 1
    s_lshl_b32 s47, s39, 10
    s_add_u32 s47, s47, 30720
    s_add_u32 s32, s47, 768
    v_lshl_add_u32 v44, v2, 3, s32
    v_add_u32 v4, 0, v3
    v_subrev_u32 v5, s45, v4
    v_cmp_gt_u32 s[48:49], 5, v5
    v_add_u32 v6, -8, v2
    v_subrev_u32 v6, s46, v6
    v_cmp_gt_u32 vcc, 18, v6
    v_mul_u32_u24 v6, 5, v6
    v_add_u32 v6, v6, v5
    s_and_b64 vcc, vcc, s[48:49]
    v_lshl_add_u32 v6, v6, 3, s47
    v_cndmask_b32 v45, v44, v6, vcc
    v_add_u32 v6, 8, v2
    v_subrev_u32 v6, s46, v6
    v_cmp_gt_u32 vcc, 18, v6
    v_mul_u32_u24 v6, 5, v6
    v_add_u32 v6, v6, v5
    s_and_b64 vcc, vcc, s[48:49]
    v_lshl_add_u32 v6, v6, 3, s47
    v_cndmask_b32 v46, v44, v6, vcc
    v_cmp_eq_u32 vcc, 0, v2
    v_add_u32 v6, 90, v5
    v_lshl_add_u32 v6, v6, 3, s47
    s_and_b64 vcc, vcc, s[48:49]
    v_cndmask_b32 v45, v45, v6, vcc
    v_add_u32 v4, 4, v3
    v_subrev_u32 v5, s45, v4
    v_cmp_gt_u32 s[48:49], 5, v5
    v_add_u32 v6, -8, v2
    v_subrev_u32 v6, s46, v6
    v_cmp_gt_u32 vcc, 18, v6
    v_mul_u32_u24 v6, 5, v6
    v_add_u32 v6, v6, v5
    s_and_b64 vcc, vcc, s[48:49]
    v_lshl_add_u32 v6, v6, 3, s47
    v_cndmask_b32 v47, v44, v6, vcc
    v_add_u32 v6, 8, v2
    v_subrev_u32 v6, s46, v6
    v_cmp_gt_u32 vcc, 18, v6
    v_mul_u32_u24 v6, 5, v6
    v_add_u32 v6, v6, v5
    s_and_b64 vcc, vcc, s[48:49]
    v_lshl_add_u32 v6, v6, 3, s47
    v_cndmask_b32 v48, v44, v6, vcc
    v_cmp_eq_u32 vcc, 0, v2
    v_add_u32 v6, 90, v5
    v_lshl_add_u32 v6, v6, 3, s47
    s_and_b64 vcc, vcc, s[48:49]
    v_cndmask_b32 v47, v47, v6, vcc
    s_mul_i32 s32, s39, 18
    s_add_u32 s32, s32, 8
    s_lshl_b32 s33, s39, 2
    s_add_u32 s33, s33, s45
    v_cmp_gt_u32 s[48:49], 2, v3
    v_lshl_add_u32 v4, v2, 1, v3
    v_add_u32 v4, 0, v4
    v_mul_u32_u24 v5, 13108, v4
    v_lshrrev_b32 v5, 16, v5
    v_mul_u32_u24 v7, 5, v5
    v_sub_u32 v6, v4, v7
    v_add_u32 v6, s33, v6
    v_add_u32 v7, s32, v5
    v_lshrrev_b32 v19, 4, v7
    v_and_b32 v7, 15, v7
    v_lshrrev_b32 v39, 2, v6
    v_and_b32 v6, 3, v6
    v_lshl_add_u32 v19, v19, 1, v39
    v_lshl_add_u32 v7, v6, 4, v7
    v_lshlrev_b32 v7, 3, v7
    v_lshl_add_u32 v7, v19, 9, v7
    v_add_u32 v7, 153088, v7
    v_cndmask_b32 v51, v44, v7, s[48:49]
    v_lshl_add_u32 v4, v2, 1, v3
    v_add_u32 v4, 32, v4
    v_mul_u32_u24 v5, 13108, v4
    v_lshrrev_b32 v5, 16, v5
    v_mul_u32_u24 v7, 5, v5
    v_sub_u32 v6, v4, v7
    v_add_u32 v6, s33, v6
    v_add_u32 v7, s32, v5
    v_lshrrev_b32 v19, 4, v7
    v_and_b32 v7, 15, v7
    v_lshrrev_b32 v39, 2, v6
    v_and_b32 v6, 3, v6
    v_lshl_add_u32 v19, v19, 1, v39
    v_lshl_add_u32 v7, v6, 4, v7
    v_lshlrev_b32 v7, 3, v7
    v_lshl_add_u32 v7, v19, 9, v7
    v_add_u32 v7, 153088, v7
    v_cndmask_b32 v52, v44, v7, s[48:49]
    v_lshl_add_u32 v4, v2, 1, v3
    v_add_u32 v4, 64, v4
    v_mul_u32_u24 v5, 13108, v4
    v_lshrrev_b32 v5, 16, v5
    v_mul_u32_u24 v7, 5, v5
    v_sub_u32 v6, v4, v7
    v_add_u32 v6, s33, v6
    v_add_u32 v7, s32, v5
    v_lshrrev_b32 v19, 4, v7
    v_and_b32 v7, 15, v7
    v_lshrrev_b32 v39, 2, v6
    v_and_b32 v6, 3, v6
    v_lshl_add_u32 v19, v19, 1, v39
    v_cmp_eq_u32 vcc, 18, v5
    v_add_u32 v39, 13, v39
    s_nop 0
    v_cndmask_b32 v19, v19, v39, vcc
    v_mov_b32 v39, s39
    v_cndmask_b32 v7, v7, v39, vcc
    v_lshl_add_u32 v7, v6, 4, v7
    v_lshlrev_b32 v7, 3, v7
    v_lshl_add_u32 v7, v19, 9, v7
    v_add_u32 v7, 153088, v7
    s_and_b64 vcc, vcc, s[48:49]
    v_cndmask_b32 v54, v44, v7, vcc
    v_cmp_gt_u32 vcc, 19, v5
    s_nop 0
    s_and_b64 s[48:49], vcc, s[48:49]
    v_cndmask_b32 v53, v44, v7, s[48:49]
    v_and_b32 v4, 1, v2
    v_lshlrev_b32 v4, 4, v4
    v_mov_b32 v5, 0x3f80
    v_lshlrev_b32 v4, v4, v5
    v_lshrrev_b32 v5, 1, v2
    v_cmp_eq_u32 vcc, 0, v5
    s_nop 1
    v_cndmask_b32 v56, 0, v4, vcc
    v_cmp_eq_u32 vcc, 1, v5
    s_nop 1
    v_cndmask_b32 v57, 0, v4, vcc
    v_cmp_eq_u32 vcc, 2, v5
    s_nop 1
    v_cndmask_b32 v58, 0, v4, vcc
    v_cmp_eq_u32 vcc, 3, v5
    s_nop 1
    v_cndmask_b32 v59, 0, v4, vcc
    v_mov_b32 v104, 0x3f803f80
    v_mov_b32 v105, 0x3f803f80
    v_mov_b32 v106, 0x3f803f80
    v_mov_b32 v107, 0x3f803f80
    ds_write_b128 v55, v[104:107] offset:16
    ds_write_b128 v55, v[40:43] offset:32
    ds_write_b32 v55, v40 offset:4
    s_add_u32 s32, s39, 0
    s_lshl_b32 s33, s32, 10
    s_add_u32 s34, s33, 104448
    s_sub_u32 s33, s33, 8192
    s_movk_i32 s48, 4096
    s_cmp_lt_u32 s32, 8
    s_cselect_b32 s33, s34, s33
    s_cselect_b32 s48, 8192, s48
    v_lshl_add_u32 v64, v1, 4, s33
    v_mov_b32 v60, s48
    v_cmp_gt_u32 vcc, s46, v2
    v_mov_b32 v4, 162336
    s_nop 0
    v_cndmask_b32 v64, v64, v4, vcc
    v_cndmask_b32 v60, v60, v40, vcc
    s_add_u32 s32, s39, 1
    s_lshl_b32 s33, s32, 10
    s_add_u32 s34, s33, 104448
    s_sub_u32 s33, s33, 8192
    s_movk_i32 s48, 4096
    s_cmp_lt_u32 s32, 8
    s_cselect_b32 s33, s34, s33
    s_cselect_b32 s48, 8192, s48
    v_lshl_add_u32 v65, v1, 4, s33
    v_mov_b32 v61, s48
    s_add_u32 s32, s46, 2
    v_cmp_le_u32 vcc, s32, v2
    v_mov_b32 v4, 162336
    s_nop 0
    v_cndmask_b32 v65, v65, v4, vcc
    v_cndmask_b32 v61, v61, v40, vcc
    s_add_u32 s32, s39, 5
    s_lshl_b32 s33, s32, 10
    s_add_u32 s34, s33, 104448
    s_sub_u32 s33, s33, 8192
    s_movk_i32 s48, 4096
    s_cmp_lt_u32 s32, 8
    s_cselect_b32 s33, s34, s33
    s_cselect_b32 s48, 8192, s48
    v_lshl_add_u32 v66, v1, 4, s33
    v_mov_b32 v62, s48
    v_cmp_eq_u32 vcc, 0, v2
    v_mov_b32 v4, 162320
    s_nop 0
    v_cndmask_b32 v66, v66, v4, vcc
    v_cndmask_b32 v62, v62, v40, vcc
    s_add_u32 s32, s39, 6
    s_lshl_b32 s33, s32, 10
    s_add_u32 s34, s33, 104448
    s_sub_u32 s33, s33, 8192
    s_movk_i32 s48, 4096
    s_cmp_lt_u32 s32, 8
    s_cselect_b32 s33, s34, s33
    s_cselect_b32 s48, 8192, s48
    v_lshl_add_u32 v67, v1, 4, s33
    v_mov_b32 v63, s48
    v_and_b32 v49, 3, v1
    v_lshlrev_b32 v49, 6, v49
    s_lshl_b32 s32, s39, 12
    s_add_u32 s32, s32, 69632
    v_lshl_add_u32 v4, v1, 4, s32
    s_mul_i32 s32, s39, 4608
    s_add_u32 s32, s32, 120832
    v_lshl_add_u32 v5, v1, 4, s32
    v_lshl_add_u32 v6, v1, 3, s32
    ds_write_b128 v5, v[44:47] offset:0
    ds_write_b128 v5, v[48:51] offset:1024
    ds_write_b128 v5, v[52:55] offset:2048
    ds_write_b128 v5, v[56:59] offset:3072
    ds_write_b64 v6, v[14:15] offset:4096
    ds_write_b128 v4, v[60:63] offset:0
    ds_write_b128 v4, v[64:67] offset:1024
    s_mov_b32 s36, 0x3fb8aa3b
    s_mov_b32 s37, s36
    s_mov_b32 s38, 0x358637bd
    s_lshl_b32 s32, s24, 12
    v_and_b32 v104, 7, v2
    v_xor_b32 v105, v3, v104
    v_lshlrev_b32 v106, 7, v2
    v_add_u32 v106, s32, v106
    v_lshl_add_u32 v4, v105, 4, v106
    v_xor_b32 v105, 4, v105
    v_lshl_add_u32 v5, v105, 4, v106
    v_lshrrev_b32 v104, 2, v2
    v_and_b32 v105, 3, v2
    v_lshlrev_b32 v105, 3, v105
    v_lshl_add_u32 v106, v3, 2, v104
    v_mul_u32_u24 v106, 288, v106
    v_add_u32 v106, v106, v105
    v_add_u32 v6, 16384, v106
    v_lshlrev_b32 v104, 1, v104
    v_lshl_add_u32 v104, v3, 3, v104
    v_mul_u32_u24 v104, 144, v104
    v_add_u32 v104, v104, v105
    v_add_u32 v7, 34816, v104
    v_cmp_gt_u32 vcc, 8, v2
    v_mov_b32 v108, s38
    v_mov_b32 v109, s38
    v_mov_b32 v110, s38
    v_mov_b32 v111, s38
    v_cndmask_b32 v104, 0, v108, vcc
    v_cndmask_b32 v105, 0, v108, vcc
    v_cndmask_b32 v106, 0, v108, vcc
    v_cndmask_b32 v107, 0, v108, vcc
    v_cmp_gt_u32 s[40:41], 2, v3
    v_cmp_gt_u32 s[42:43], 3, v3
    s_waitcnt lgkmcnt(0)
    s_mov_b64 s[10:11], s[52:53]
    s_mov_b64 s[14:15], s[56:57]
    s_branch L_sec_cmain
L_sec_loader:
    v_add_u32 v4, 0, v1
    v_mul_u32_u24 v5, 7282, v4
    v_lshrrev_b32 v5, 16, v5
    v_mul_u32_u24 v7, 9, v5
    v_sub_u32 v6, v4, v7
    v_lshlrev_b32 v6, 4, v6
    v_add_u32 v6, s40, v6
    v_lshrrev_b32 v4, 3, v5
    v_and_b32 v7, 1, v5
    v_bfe_u32 v5, v5, 1, 2
    v_lshl_add_u32 v19, v7, 2, v5
    v_lshl_add_u32 v39, v4, 3, v19
    v_mul_u32_u24 v39, 3456, v39
    v_add_u32 v24, v39, v6
    v_lshl_add_u32 v39, v4, 2, v5
    v_lshl_add_u32 v39, v7, 4, v39
    v_mul_u32_u24 v39, 1152, v39
    v_add_u32 v29, v39, v6
    v_mul_u32_u24 v39, 72, v4
    v_add_u32 v39, v39, v19
    v_mul_u32_u24 v39, 1152, v39
    v_add_u32 v34, v39, v6
    v_add_u32 v4, 64, v1
    v_mul_u32_u24 v5, 7282, v4
    v_lshrrev_b32 v5, 16, v5
    v_mul_u32_u24 v7, 9, v5
    v_sub_u32 v6, v4, v7
    v_lshlrev_b32 v6, 4, v6
    v_add_u32 v6, s40, v6
    v_lshrrev_b32 v4, 3, v5
    v_and_b32 v7, 1, v5
    v_bfe_u32 v5, v5, 1, 2
    v_lshl_add_u32 v19, v7, 2, v5
    v_lshl_add_u32 v39, v4, 3, v19
    v_mul_u32_u24 v39, 3456, v39
    v_add_u32 v25, v39, v6
    v_lshl_add_u32 v39, v4, 2, v5
    v_lshl_add_u32 v39, v7, 4, v39
    v_mul_u32_u24 v39, 1152, v39
    v_add_u32 v30, v39, v6
    v_mul_u32_u24 v39, 72, v4
    v_add_u32 v39, v39, v19
    v_mul_u32_u24 v39, 1152, v39
    v_add_u32 v35, v39, v6
    v_add_u32 v4, 128, v1
    v_mul_u32_u24 v5, 7282, v4
    v_lshrrev_b32 v5, 16, v5
    v_mul_u32_u24 v7, 9, v5
    v_sub_u32 v6, v4, v7
    v_lshlrev_b32 v6, 4, v6
    v_add_u32 v6, s40, v6
    v_lshrrev_b32 v4, 3, v5
    v_and_b32 v7, 1, v5
    v_bfe_u32 v5, v5, 1, 2
    v_lshl_add_u32 v19, v7, 2, v5
    v_lshl_add_u32 v39, v4, 3, v19
    v_mul_u32_u24 v39, 3456, v39
    v_add_u32 v26, v39, v6
    v_lshl_add_u32 v39, v4, 2, v5
    v_lshl_add_u32 v39, v7, 4, v39
    v_mul_u32_u24 v39, 1152, v39
    v_add_u32 v31, v39, v6
    v_mul_u32_u24 v39, 72, v4
    v_add_u32 v39, v39, v19
    v_mul_u32_u24 v39, 1152, v39
    v_add_u32 v36, v39, v6
    v_add_u32 v4, 192, v1
    v_mul_u32_u24 v5, 7282, v4
    v_lshrrev_b32 v5, 16, v5
    v_mul_u32_u24 v7, 9, v5
    v_sub_u32 v6, v4, v7
    v_lshlrev_b32 v6, 4, v6
    v_add_u32 v6, s40, v6
    v_lshrrev_b32 v4, 3, v5
    v_and_b32 v7, 1, v5
    v_bfe_u32 v5, v5, 1, 2
    v_lshl_add_u32 v19, v7, 2, v5
    v_lshl_add_u32 v39, v4, 3, v19
    v_mul_u32_u24 v39, 3456, v39
    v_add_u32 v27, v39, v6
    v_lshl_add_u32 v39, v4, 2, v5
    v_lshl_add_u32 v39, v7, 4, v39
    v_mul_u32_u24 v39, 1152, v39
    v_add_u32 v32, v39, v6
    v_mul_u32_u24 v39, 72, v4
    v_add_u32 v39, v39, v19
    v_mul_u32_u24 v39, 1152, v39
    v_add_u32 v37, v39, v6
    v_add_u32 v4, 256, v1
    v_mul_u32_u24 v5, 7282, v4
    v_lshrrev_b32 v5, 16, v5
    v_mul_u32_u24 v7, 9, v5
    v_sub_u32 v6, v4, v7
    v_lshlrev_b32 v6, 4, v6
    v_add_u32 v6, s40, v6
    v_lshrrev_b32 v4, 3, v5
    v_and_b32 v7, 1, v5
    v_bfe_u32 v5, v5, 1, 2
    v_lshl_add_u32 v19, v7, 2, v5
    v_lshl_add_u32 v39, v4, 3, v19
    v_mul_u32_u24 v39, 3456, v39
    v_add_u32 v28, v39, v6
    v_lshl_add_u32 v39, v4, 2, v5
    v_lshl_add_u32 v39, v7, 4, v39
    v_mul_u32_u24 v39, 1152, v39
    v_add_u32 v33, v39, v6
    v_mul_u32_u24 v39, 72, v4
    v_add_u32 v39, v39, v19
    v_mul_u32_u24 v39, 1152, v39
    v_add_u32 v38, v39, v6
    s_mul_i32 s58, s39, 110592
    s_lshl_b32 s47, s39, 10
    s_add_u32 s47, s47, 30720
    v_mov_b32 v40, 0
    v_mov_b32 v41, 0
    s_lshl_b32 s3, s43, 7
    s_mul_i32 s35, s43, 221184
    s_add_u32 m0, s41, 34816
    s_nop 0
    buffer_load_dwordx4 v8, s[16:19], s3 offen lds
    s_add_u32 m0, s41, 35840
    s_add_u32 s3, s3, 9216
    buffer_load_dwordx4 v8, s[16:19], s3 offen lds
    s_add_u32 m0, s41, 36864
    s_add_u32 s3, s3, 9216
    buffer_load_dwordx4 v8, s[16:19], s3 offen lds
    s_add_u32 m0, s41, 37888
    s_add_u32 s3, s3, 9216
    buffer_load_dwordx4 v8, s[16:19], s3 offen lds
    s_add_u32 m0, s42, 34816
    s_nop 0
    buffer_load_dwordx4 v9, s[20:23], s35 offen lds
    s_add_u32 m0, s42, 35840
    s_nop 0
    buffer_load_dwordx4 v10, s[20:23], s35 offen lds
    s_add_u32 m0, s42, 36864
    s_nop 0
    buffer_load_dwordx4 v11, s[20:23], s35 offen lds
    s_add_u32 m0, s42, 37888
    s_nop 0
    buffer_load_dwordx4 v12, s[20:23], s35 offen lds
    s_add_u32 m0, s42, 38912
    s_mov_b32 exec_hi, 0
    buffer_load_dwordx4 v13, s[20:23], s35 offen lds
    s_mov_b32 exec_hi, -1
    s_add_u32 s43, s43, 1
    s_cmp_eq_u32 s43, 9
    s_cselect_b32 s43, 0, s43
    s_waitcnt vmcnt(9)
    s_barrier
    s_lshl_b32 s32, s39, 12
    s_add_u32 s32, s32, 69632
    v_lshl_add_u32 v4, v1, 4, s32
    s_mul_i32 s32, s39, 4608
    s_add_u32 s32, s32, 120832
    v_lshl_add_u32 v5, v1, 4, s32
    v_lshl_add_u32 v6, v1, 3, s32
    ds_read_b128 v[44:47], v5 offset:0
    ds_read_b128 v[48:51], v5 offset:1024
    ds_read_b128 v[52:55], v5 offset:2048
    ds_read_b128 v[56:59], v5 offset:3072
    ds_read_b64 v[14:15], v6 offset:4096
    ds_read_b128 v[60:63], v4 offset:0
    ds_read_b128 v[64:67], v4 offset:1024
    s_waitcnt lgkmcnt(0)
    s_lshl_b32 s3, s43, 7
    s_mul_i32 s35, s43, 221184
    s_add_u32 m0, s41, 69632
    s_nop 0
    buffer_load_dwordx4 v8, s[16:19], s3 offen lds
    s_add_u32 m0, s41, 70656
    s_add_u32 s3, s3, 9216
    buffer_load_dwordx4 v8, s[16:19], s3 offen lds
    s_add_u32 m0, s41, 71680
    s_add_u32 s3, s3, 9216
    buffer_load_dwordx4 v8, s[16:19], s3 offen lds
    s_add_u32 m0, s41, 72704
    s_add_u32 s3, s3, 9216
    buffer_load_dwordx4 v8, s[16:19], s3 offen lds
    s_add_u32 m0, s42, 69632
    s_nop 0
    buffer_load_dwordx4 v9, s[20:23], s35 offen lds
    s_add_u32 m0, s42, 70656
    s_nop 0
    buffer_load_dwordx4 v10, s[20:23], s35 offen lds
    s_add_u32 m0, s42, 71680
    s_nop 0
    buffer_load_dwordx4 v11, s[20:23], s35 offen lds
    s_add_u32 m0, s42, 72704
    s_nop 0
    buffer_load_dwordx4 v12, s[20:23], s35 offen lds
    s_add_u32 m0, s42, 73728
    s_mov_b32 exec_hi, 0
    buffer_load_dwordx4 v13, s[20:23], s35 offen lds
    s_mov_b32 exec_hi, -1
    s_add_u32 s43, s43, 1
    s_cmp_eq_u32 s43, 9
    s_cselect_b32 s43, 0, s43
    s_waitcnt vmcnt(9)
    s_barrier
    s_lshl_b32 s3, s43, 7
    s_mul_i32 s35, s43, 221184
    s_add_u32 m0, s41, 104448
    s_nop 0
    buffer_load_dwordx4 v8, s[16:19], s3 offen lds
    s_add_u32 m0, s41, 105472
    s_add_u32 s3, s3, 9216
    buffer_load_dwordx4 v8, s[16:19], s3 offen lds
    s_add_u32 m0, s41, 106496
    s_add_u32 s3, s3, 9216
    buffer_load_dwordx4 v8, s[16:19], s3 offen lds
    s_add_u32 m0, s41, 107520
    s_add_u32 s3, s3, 9216
    buffer_load_dwordx4 v8, s[16:19], s3 offen lds
    s_add_u32 m0, s42, 104448
    s_nop 0
    buffer_load_dwordx4 v9, s[20:23], s35 offen lds
    s_add_u32 m0, s42, 105472
    s_nop 0
    buffer_load_dwordx4 v10, s[20:23], s35 offen lds
    s_add_u32 m0, s42, 106496
    s_nop 0
    buffer_load_dwordx4 v11, s[20:23], s35 offen lds
    s_add_u32 m0, s42, 107520
    s_nop 0
    buffer_load_dwordx4 v12, s[20:23], s35 offen lds
    s_add_u32 m0, s42, 108544
    s_mov_b32 exec_hi, 0
    buffer_load_dwordx4 v13, s[20:23], s35 offen lds
    s_mov_b32 exec_hi, -1
    s_add_u32 s43, s43, 1
    s_cmp_eq_u32 s43, 9
    s_cselect_b32 s43, 0, s43
    s_waitcnt vmcnt(9)
    s_barrier
    s_lshl_b32 s3, s43, 7
    s_mul_i32 s35, s43, 221184
    s_add_u32 m0, s41, 0
    s_nop 0
    buffer_load_dwordx4 v8, s[16:19], s3 offen lds
    s_add_u32 m0, s41, 1024
    s_add_u32 s3, s3, 9216
    buffer_load_dwordx4 v8, s[16:19], s3 offen lds
    s_add_u32 m0, s41, 2048
    s_add_u32 s3, s3, 9216
    buffer_load_dwordx4 v8, s[16:19], s3 offen lds
    s_add_u32 m0, s41, 3072
    s_add_u32 s3, s3, 9216
    buffer_load_dwordx4 v8, s[16:19], s3 offen lds
    s_add_u32 m0, s42, 0
    s_nop 0
    buffer_load_dwordx4 v9, s[20:23], s35 offen lds
    s_add_u32 m0, s42, 1024
    s_nop 0
    buffer_load_dwordx4 v10, s[20:23], s35 offen lds
    s_add_u32 m0, s42, 2048
    s_nop 0
    buffer_load_dwordx4 v11, s[20:23], s35 offen lds
    s_add_u32 m0, s42, 3072
    s_nop 0
    buffer_load_dwordx4 v12, s[20:23], s35 offen lds
    s_add_u32 m0, s42, 4096
    s_mov_b32 exec_hi, 0
    buffer_load_dwordx4 v13, s[20:23], s35 offen lds
    s_mov_b32 exec_hi, -1
    s_add_u32 s43, s43, 1
    s_cmp_eq_u32 s43, 9
    s_cselect_b32 s43, 0, s43
    s_waitcnt vmcnt(9)
    s_barrier
    s_lshl_b32 s3, s43, 7
    s_mul_i32 s35, s43, 221184
    s_add_u32 m0, s41, 34816
    s_nop 0
    buffer_load_dwordx4 v8, s[16:19], s3 offen lds
    s_add_u32 m0, s41, 35840
    s_add_u32 s3, s3, 9216
    buffer_load_dwordx4 v8, s[16:19], s3 offen lds
    s_add_u32 m0, s41, 36864
    s_add_u32 s3, s3, 9216
    buffer_load_dwordx4 v8, s[16:19], s3 offen lds
    s_add_u32 m0, s41, 37888
    s_add_u32 s3, s3, 9216
    buffer_load_dwordx4 v8, s[16:19], s3 offen lds
    s_add_u32 m0, s42, 34816
    s_nop 0
    buffer_load_dwordx4 v9, s[20:23], s35 offen lds
    s_add_u32 m0, s42, 35840
    s_nop 0
    buffer_load_dwordx4 v10, s[20:23], s35 offen lds
    s_add_u32 m0, s42, 36864
    s_nop 0
    buffer_load_dwordx4 v11, s[20:23], s35 offen lds
    s_add_u32 m0, s42, 37888
    s_nop 0
    buffer_load_dwordx4 v12, s[20:23], s35 offen lds
    s_add_u32 m0, s42, 38912
    s_mov_b32 exec_hi, 0
    buffer_load_dwordx4 v13, s[20:23], s35 offen lds
    s_mov_b32 exec_hi, -1
    s_add_u32 s43, s43, 1
    s_cmp_eq_u32 s43, 9
    s_cselect_b32 s43, 0, s43
    s_waitcnt vmcnt(9)
    s_barrier
    s_lshl_b32 s3, s43, 7
    s_mul_i32 s35, s43, 221184
    s_add_u32 m0, s41, 69632
    s_nop 0
    buffer_load_dwordx4 v8, s[16:19], s3 offen lds
    s_add_u32 m0, s41, 70656
    s_add_u32 s3, s3, 9216
    buffer_load_dwordx4 v8, s[16:19], s3 offen lds
    s_add_u32 m0, s41, 71680
    s_add_u32 s3, s3, 9216
    buffer_load_dwordx4 v8, s[16:19], s3 offen lds
    s_add_u32 m0, s41, 72704
    s_add_u32 s3, s3, 9216
    buffer_load_dwordx4 v8, s[16:19], s3 offen lds
    s_add_u32 m0, s42, 69632
    s_nop 0
    buffer_load_dwordx4 v9, s[20:23], s35 offen lds
    s_add_u32 m0, s42, 70656
    s_nop 0
    buffer_load_dwordx4 v10, s[20:23], s35 offen lds
    s_add_u32 m0, s42, 71680
    s_nop 0
    buffer_load_dwordx4 v11, s[20:23], s35 offen lds
    s_add_u32 m0, s42, 72704
    s_nop 0
    buffer_load_dwordx4 v12, s[20:23], s35 offen lds
    s_add_u32 m0, s42, 73728
    s_mov_b32 exec_hi, 0
    buffer_load_dwordx4 v13, s[20:23], s35 offen lds
    s_mov_b32 exec_hi, -1
    s_add_u32 s43, s43, 1
    s_cmp_eq_u32 s43, 9
    s_cselect_b32 s43, 0, s43
    s_waitcnt vmcnt(9)
    s_barrier
    s_lshl_b32 s3, s43, 7
    s_mul_i32 s35, s43, 221184
    s_add_u32 m0, s41, 104448
    s_nop 0
    buffer_load_dwordx4 v8, s[16:19], s3 offen lds
    s_add_u32 m0, s41, 105472
    s_add_u32 s3, s3, 9216
    buffer_load_dwordx4 v8, s[16:19], s3 offen lds
    s_add_u32 m0, s41, 106496
    s_add_u32 s3, s3, 9216
    buffer_load_dwordx4 v8, s[16:19], s3 offen lds
    s_add_u32 m0, s41, 107520
    s_add_u32 s3, s3, 9216
    buffer_load_dwordx4 v8, s[16:19], s3 offen lds
    s_add_u32 m0, s42, 104448
    s_nop 0
    buffer_load_dwordx4 v9, s[20:23], s35 offen lds
    s_add_u32 m0, s42, 105472
    s_nop 0
    buffer_load_dwordx4 v10, s[20:23], s35 offen lds
    s_add_u32 m0, s42, 106496
    s_nop 0
    buffer_load_dwordx4 v11, s[20:23], s35 offen lds
    s_add_u32 m0, s42, 107520
    s_nop 0
    buffer_load_dwordx4 v12, s[20:23], s35 offen lds
    s_add_u32 m0, s42, 108544
    s_mov_b32 exec_hi, 0
    buffer_load_dwordx4 v13, s[20:23], s35 offen lds
    s_mov_b32 exec_hi, -1
    s_add_u32 s43, s43, 1
    s_cmp_eq_u32 s43, 9
    s_cselect_b32 s43, 0, s43
    s_waitcnt vmcnt(9)
    s_barrier
    s_lshl_b32 s3, s43, 7
    s_mul_i32 s35, s43, 221184
    s_add_u32 m0, s41, 0
    s_nop 0
    buffer_load_dwordx4 v8, s[16:19], s3 offen lds
    s_add_u32 m0, s41, 1024
    s_add_u32 s3, s3, 9216
    buffer_load_dwordx4 v8, s[16:19], s3 offen lds
    s_add_u32 m0, s41, 2048
    s_add_u32 s3, s3, 9216
    buffer_load_dwordx4 v8, s[16:19], s3 offen lds
    s_add_u32 m0, s41, 3072
    s_add_u32 s3, s3, 9216
    buffer_load_dwordx4 v8, s[16:19], s3 offen lds
    s_add_u32 m0, s42, 0
    s_nop 0
    buffer_load_dwordx4 v9, s[20:23], s35 offen lds
    s_add_u32 m0, s42, 1024
    s_nop 0
    buffer_load_dwordx4 v10, s[20:23], s35 offen lds
    s_add_u32 m0, s42, 2048
    s_nop 0
    buffer_load_dwordx4 v11, s[20:23], s35 offen lds
    s_add_u32 m0, s42, 3072
    s_nop 0
    buffer_load_dwordx4 v12, s[20:23], s35 offen lds
    s_add_u32 m0, s42, 4096
    s_mov_b32 exec_hi, 0
    buffer_load_dwordx4 v13, s[20:23], s35 offen lds
    s_mov_b32 exec_hi, -1
    s_add_u32 s43, s43, 1
    s_cmp_eq_u32 s43, 9
    s_cselect_b32 s43, 0, s43
    s_waitcnt vmcnt(9)
    s_barrier
    s_add_u32 s32, s58, 0
    s_add_u32 s34, s42, 18432
    s_add_u32 m0, s34, 0
    s_nop 0
    buffer_load_dwordx4 v24, s[20:23], s32 offen lds
    s_add_u32 m0, s34, 1024
    s_nop 0
    buffer_load_dwordx4 v25, s[20:23], s32 offen lds
    s_add_u32 m0, s34, 2048
    s_nop 0
    buffer_load_dwordx4 v26, s[20:23], s32 offen lds
    s_add_u32 m0, s34, 3072
    s_nop 0
    buffer_load_dwordx4 v27, s[20:23], s32 offen lds
    s_add_u32 m0, s34, 4096
    s_mov_b32 exec_hi, 0
    buffer_load_dwordx4 v28, s[20:23], s32 offen lds
    s_mov_b32 exec_hi, -1
    s_waitcnt vmcnt(5)
    s_barrier
    s_add_u32 s32, s58, 442368
    s_add_u32 s34, s42, 36864
    s_add_u32 m0, s34, 0
    s_nop 0
    buffer_load_dwordx4 v24, s[20:23], s32 offen lds
    s_add_u32 m0, s34, 1024
    s_nop 0
    buffer_load_dwordx4 v25, s[20:23], s32 offen lds
    s_add_u32 m0, s34, 2048
    s_nop 0
    buffer_load_dwordx4 v26, s[20:23], s32 offen lds
    s_add_u32 m0, s34, 3072
    s_nop 0
    buffer_load_dwordx4 v27, s[20:23], s32 offen lds
    s_add_u32 m0, s34, 4096
    s_mov_b32 exec_hi, 0
    buffer_load_dwordx4 v28, s[20:23], s32 offen lds
    s_mov_b32 exec_hi, -1
    s_add_u32 s32, s58, 884736
    s_add_u32 s34, s42, 55296
    s_add_u32 m0, s34, 0
    s_nop 0
    buffer_load_dwordx4 v24, s[20:23], s32 offen lds
    s_add_u32 m0, s34, 1024
    s_nop 0
    buffer_load_dwordx4 v25, s[20:23], s32 offen lds
    s_add_u32 m0, s34, 2048
    s_nop 0
    buffer_load_dwordx4 v26, s[20:23], s32 offen lds
    s_add_u32 m0, s34, 3072
    s_nop 0
    buffer_load_dwordx4 v27, s[20:23], s32 offen lds
    s_add_u32 m0, s34, 4096
    s_mov_b32 exec_hi, 0
    buffer_load_dwordx4 v28, s[20:23], s32 offen lds
    s_mov_b32 exec_hi, -1
    s_cmp_lg_u32 s39, 0
    s_nop 0
    s_cbranch_scc1 L_b_nocnt
    s_mov_b64 exec, 15
    global_load_dword v20, v49, s[12:13] sc1
    s_mov_b64 exec, -1
L_b_nocnt:
    s_add_u32 s35, s39, 12
    s_lshr_b32 s32, s35, 1
    s_add_u32 s32, s32, s27
    s_sub_u32 s33, s32, 9
    s_cmp_ge_u32 s32, 9
    s_cselect_b32 s32, s33, s32
    s_lshl_b32 s32, s32, 1
    s_and_b32 s33, s35, 1
    s_add_u32 s32, s32, s33
    s_mul_i32 s32, s32, 110592
    s_mul_i32 s34, s35, 4608
    s_add_u32 s33, s34, 35328
    s_cmp_ge_u32 s35, 15
    s_cselect_b32 s34, s33, s34
    s_add_u32 s34, s34, 34816
    s_add_u32 m0, s34, 0
    s_nop 0
    buffer_load_dwordx4 v24, s[20:23], s32 offen lds
    s_add_u32 m0, s34, 1024
    s_nop 0
    buffer_load_dwordx4 v25, s[20:23], s32 offen lds
    s_add_u32 m0, s34, 2048
    s_nop 0
    buffer_load_dwordx4 v26, s[20:23], s32 offen lds
    s_add_u32 m0, s34, 3072
    s_nop 0
    buffer_load_dwordx4 v27, s[20:23], s32 offen lds
    s_add_u32 m0, s34, 4096
    s_mov_b32 exec_hi, 0
    buffer_load_dwordx4 v28, s[20:23], s32 offen lds
    s_mov_b32 exec_hi, -1
    s_add_u32 s35, s39, 16
    s_min_u32 s35, s35, 17
    s_lshr_b32 s32, s35, 1
    s_add_u32 s32, s32, s27
    s_sub_u32 s33, s32, 9
    s_cmp_ge_u32 s32, 9
    s_cselect_b32 s32, s33, s32
    s_lshl_b32 s32, s32, 1
    s_and_b32 s33, s35, 1
    s_add_u32 s32, s32, s33
    s_mul_i32 s32, s32, 110592
    s_mul_i32 s34, s35, 4608
    s_add_u32 s33, s34, 35328
    s_cmp_ge_u32 s35, 15
    s_cselect_b32 s34, s33, s34
    s_add_u32 s34, s34, 34816
    s_add_u32 m0, s34, 0
    s_nop 0
    buffer_load_dwordx4 v24, s[20:23], s32 offen lds
    s_add_u32 m0, s34, 1024
    s_nop 0
    buffer_load_dwordx4 v25, s[20:23], s32 offen lds
    s_add_u32 m0, s34, 2048
    s_nop 0
    buffer_load_dwordx4 v26, s[20:23], s32 offen lds
    s_add_u32 m0, s34, 3072
    s_nop 0
    buffer_load_dwordx4 v27, s[20:23], s32 offen lds
    s_add_u32 m0, s34, 4096
    s_mov_b32 exec_hi, 0
    buffer_load_dwordx4 v28, s[20:23], s32 offen lds
    s_mov_b32 exec_hi, -1
    s_waitcnt vmcnt(10)
    s_cmp_lg_u32 s39, 0
    s_cbranch_scc1 L_b_cntdone
    s_mov_b64 exec, 15
    v_cmp_gt_u32 vcc, 12, v20
    s_nop 0
    s_cbranch_vccz L_b_cntdone
    s_mov_b32 s44, 20000
L_b_cnt:
    global_load_dword v20, v49, s[12:13] sc1
    s_sub_u32 s44, s44, 1
    s_cbranch_scc1 L_b_cntdone
    s_waitcnt vmcnt(0)
    v_cmp_gt_u32 vcc, 12, v20
    s_nop 0
    s_nop 0
    s_cbranch_vccnz L_b_cnt
L_b_cntdone:
    s_mov_b64 exec, -1
    s_waitcnt lgkmcnt(0)
    s_barrier
    s_setprio 2
    ds_read_b128 a[0:3], v64
    v_add_u32 v64, v60, v64
    ds_read_b128 a[4:7], v65
    v_add_u32 v65, v61, v65
    ds_read_b128 a[8:11], v66
    v_add_u32 v66, v62, v66
    ds_read_b128 a[12:15], v67
    v_add_u32 v67, v63, v67
    ds_read_b128 a[16:19], v64
    v_add_u32 v64, v60, v64
    ds_read_b128 a[20:23], v65
    v_add_u32 v65, v61, v65
    ds_read_b128 a[24:27], v66
    v_add_u32 v66, v62, v66
    ds_read_b128 a[28:31], v67
    v_add_u32 v67, v63, v67
    ds_read_b128 a[32:35], v64
    v_add_u32 v64, v60, v64
    ds_read_b128 a[36:39], v65
    v_add_u32 v65, v61, v65
    ds_read_b128 a[40:43], v66
    v_add_u32 v66, v62, v66
    ds_read_b128 a[44:47], v67
    v_add_u32 v67, v63, v67
    ds_read_b128 a[48:51], v64
    ds_read_b128 a[52:55], v65
    ds_read_b128 a[56:59], v66
    ds_read_b128 a[60:63], v67
    v_mov_b32 v4, s47
    v_mov_b32 v5, 1
    ds_write_b64 v4, v[40:41] offset:760
    s_waitcnt lgkmcnt(13)
    v_mfma_f32_16x16x32_bf16 v[68:71], a[0:3], a[8:11], 0
    v_mfma_f32_16x16x32_bf16 v[72:75], a[0:3], a[12:15], 0
    v_mfma_f32_16x16x32_bf16 v[76:79], a[4:7], a[8:11], 0
    v_mfma_f32_16x16x32_bf16 v[80:83], a[4:7], a[12:15], 0
    s_waitcnt lgkmcnt(9)
    v_mfma_f32_16x16x32_bf16 v[68:71], a[16:19], a[24:27], v[68:71]
    v_mfma_f32_16x16x32_bf16 v[72:75], a[16:19], a[28:31], v[72:75]
    v_mfma_f32_16x16x32_bf16 v[76:79], a[20:23], a[24:27], v[76:79]
    v_mfma_f32_16x16x32_bf16 v[80:83], a[20:23], a[28:31], v[80:83]
    s_waitcnt lgkmcnt(5)
    v_mfma_f32_16x16x32_bf16 v[68:71], a[32:35], a[40:43], v[68:71]
    v_mfma_f32_16x16x32_bf16 v[72:75], a[32:35], a[44:47], v[72:75]
    v_mfma_f32_16x16x32_bf16 v[76:79], a[36:39], a[40:43], v[76:79]
    v_mfma_f32_16x16x32_bf16 v[80:83], a[36:39], a[44:47], v[80:83]
    s_waitcnt lgkmcnt(1)
    s_mov_b64 exec, 1
    ds_add_u32 v55, v5
    s_mov_b64 exec, -1
    v_mfma_f32_16x16x32_bf16 v[68:71], a[48:51], a[56:59], v[68:71]
    v_mfma_f32_16x16x32_bf16 v[72:75], a[48:51], a[60:63], v[72:75]
    v_mfma_f32_16x16x32_bf16 v[76:79], a[52:55], a[56:59], v[76:79]
    v_mfma_f32_16x16x32_bf16 v[80:83], a[52:55], a[60:63], v[80:83]
    v_lshl_add_u32 v4, v1, 4, s47
    v_add_u32 v16, 4096, v15
    v_add_u32 v17, 8192, v15
    s_nop 1
    v_cvt_pk_bf16_f32 v92, v68, v69
    v_cvt_pk_bf16_f32 v93, v70, v71
    ds_write_b64 v45, v[92:93]
    v_cvt_pk_bf16_f32 v94, v72, v73
    v_cvt_pk_bf16_f32 v95, v74, v75
    ds_write_b64 v46, v[94:95]
    v_cvt_pk_bf16_f32 v96, v76, v77
    v_cvt_pk_bf16_f32 v97, v78, v79
    ds_write_b64 v47, v[96:97]
    v_cvt_pk_bf16_f32 v98, v80, v81
    v_cvt_pk_bf16_f32 v99, v82, v83
    ds_write_b64 v48, v[98:99]
    ds_read_b128 v[68:71], v4
    s_waitcnt vmcnt(0)
    s_mov_b64 exec, 1
    ds_add_u32 v55, v5 offset:4
    s_mov_b64 exec, -1
    s_waitcnt lgkmcnt(1)
    v_min_u32 v68, -2, v68
    s_mov_b32 exec_hi, 0xffff
    global_store_dwordx4 v14, v[68:71], s[14:15] sc1
    s_mov_b32 exec_hi, -1
    s_mov_b32 s44, 20000
L_b_lcnt:
    ds_read_b32 v4, v55
    s_sub_u32 s44, s44, 1
    s_nop 0
    s_cbranch_scc1 L_b_lcntdone
    s_waitcnt lgkmcnt(0)
    v_cmp_gt_u32 vcc, 4, v4
    s_nop 0
    s_nop 0
    s_cbranch_vccnz L_b_lcnt
L_b_lcntdone:
    s_waitcnt lgkmcnt(0)
    s_add_u32 s35, s39, 0
    s_lshr_b32 s32, s35, 1
    s_add_u32 s32, s32, s26
    s_and_b32 s32, s32, 7
    s_mul_i32 s32, s32, 72
    s_and_b32 s33, s35, 1
    s_lshl_b32 s33, s33, 5
    s_add_u32 s32, s32, s33
    s_add_u32 s32, s32, 8
    s_mul_i32 s32, s32, 1152
    s_mul_i32 s34, s35, 4608
    s_add_u32 s33, s34, 76800
    s_cmp_ge_u32 s35, 6
    s_cselect_b32 s34, s33, s34
    s_add_u32 m0, s34, 0
    s_nop 0
    buffer_load_dwordx4 v29, s[28:31], s32 offen lds
    s_add_u32 m0, s34, 1024
    s_nop 0
    buffer_load_dwordx4 v30, s[28:31], s32 offen lds
    s_add_u32 m0, s34, 2048
    s_nop 0
    buffer_load_dwordx4 v31, s[28:31], s32 offen lds
    s_add_u32 m0, s34, 3072
    s_nop 0
    buffer_load_dwordx4 v32, s[28:31], s32 offen lds
    s_add_u32 m0, s34, 4096
    s_mov_b32 exec_hi, 0
    buffer_load_dwordx4 v33, s[28:31], s32 offen lds
    s_mov_b32 exec_hi, -1
    s_add_u32 s35, s39, 4
    s_lshr_b32 s32, s35, 1
    s_add_u32 s32, s32, s26
    s_and_b32 s32, s32, 7
    s_mul_i32 s32, s32, 72
    s_and_b32 s33, s35, 1
    s_lshl_b32 s33, s33, 5
    s_add_u32 s32, s32, s33
    s_add_u32 s32, s32, 8
    s_mul_i32 s32, s32, 1152
    s_mul_i32 s34, s35, 4608
    s_add_u32 s33, s34, 76800
    s_cmp_ge_u32 s35, 6
    s_cselect_b32 s34, s33, s34
    s_add_u32 m0, s34, 0
    s_nop 0
    buffer_load_dwordx4 v29, s[28:31], s32 offen lds
    s_add_u32 m0, s34, 1024
    s_nop 0
    buffer_load_dwordx4 v30, s[28:31], s32 offen lds
    s_add_u32 m0, s34, 2048
    s_nop 0
    buffer_load_dwordx4 v31, s[28:31], s32 offen lds
    s_add_u32 m0, s34, 3072
    s_nop 0
    buffer_load_dwordx4 v32, s[28:31], s32 offen lds
    s_add_u32 m0, s34, 4096
    s_mov_b32 exec_hi, 0
    buffer_load_dwordx4 v33, s[28:31], s32 offen lds
    s_mov_b32 exec_hi, -1
    s_add_u32 s35, s39, 8
    s_lshr_b32 s32, s35, 1
    s_add_u32 s32, s32, s26
    s_and_b32 s32, s32, 7
    s_mul_i32 s32, s32, 72
    s_and_b32 s33, s35, 1
    s_lshl_b32 s33, s33, 5
    s_add_u32 s32, s32, s33
    s_add_u32 s32, s32, 8
    s_mul_i32 s32, s32, 1152
    s_mul_i32 s34, s35, 4608
    s_add_u32 s33, s34, 76800
    s_cmp_ge_u32 s35, 6
    s_cselect_b32 s34, s33, s34
    s_add_u32 m0, s34, 0
    s_nop 0
    buffer_load_dwordx4 v29, s[28:31], s32 offen lds
    s_add_u32 m0, s34, 1024
    s_nop 0
    buffer_load_dwordx4 v30, s[28:31], s32 offen lds
    s_add_u32 m0, s34, 2048
    s_nop 0
    buffer_load_dwordx4 v31, s[28:31], s32 offen lds
    s_add_u32 m0, s34, 3072
    s_nop 0
    buffer_load_dwordx4 v32, s[28:31], s32 offen lds
    s_add_u32 m0, s34, 4096
    s_mov_b32 exec_hi, 0
    buffer_load_dwordx4 v33, s[28:31], s32 offen lds
    s_mov_b32 exec_hi, -1
    v_lshlrev_b32 v4, 8, v2
    v_lshlrev_b32 v6, 4, v1
    v_sub_u32 v5, v17, v6
    v_add_u32 v4, v4, v5
    s_mov_b32 s44, 20000
    s_cmp_lg_u32 s39, 0
    s_nop 0
    s_cbranch_scc1 L_b_gather
    s_mov_b64 exec, 15
    global_load_dword v50, v49, s[12:13] offset:4 sc1
    s_mov_b64 exec, -1
L_b_gather:
    global_load_dwordx4 v[64:67], v15, s[14:15] offset:0 sc1
    global_load_dwordx4 v[68:71], v15, s[14:15] offset:1024 sc1
    global_load_dwordx4 v[72:75], v15, s[14:15] offset:2048 sc1
    global_load_dwordx4 v[76:79], v15, s[14:15] offset:3072 sc1
    global_load_dwordx4 v[80:83], v16, s[14:15] offset:0 sc1
    global_load_dwordx4 v[84:87], v16, s[14:15] offset:1024 sc1
    global_load_dwordx4 v[88:91], v16, s[14:15] offset:2048 sc1
    global_load_dwordx4 v[92:95], v16, s[14:15] offset:3072 sc1
    global_load_dwordx4 v[96:99], v17, s[14:15] offset:0 sc1
    global_load_dwordx4 v[100:103], v17, s[14:15] offset:1024 sc1
    global_load_dwordx4 v[104:107], v17, s[14:15] offset:2048 sc1
    global_load_dwordx4 v[108:111], v17, s[14:15] offset:3072 sc1
    s_mov_b64 s[32:33], 0
    s_waitcnt vmcnt(8)
    v_cmp_eq_u32 vcc, -1, v64
    s_nop 0
    s_or_b64 s[32:33], s[32:33], vcc
    v_cmp_eq_u32 vcc, -1, v68
    s_nop 0
    s_or_b64 s[32:33], s[32:33], vcc
    v_cmp_eq_u32 vcc, -1, v72
    s_nop 0
    s_or_b64 s[32:33], s[32:33], vcc
    v_cmp_eq_u32 vcc, -1, v76
    s_nop 0
    s_or_b64 s[32:33], s[32:33], vcc
    s_waitcnt vmcnt(4)
    v_cmp_eq_u32 vcc, -1, v80
    s_nop 0
    s_or_b64 s[32:33], s[32:33], vcc
    v_cmp_eq_u32 vcc, -1, v84
    s_nop 0
    s_or_b64 s[32:33], s[32:33], vcc
    v_cmp_eq_u32 vcc, -1, v88
    s_nop 0
    s_or_b64 s[32:33], s[32:33], vcc
    v_cmp_eq_u32 vcc, -1, v92
    s_nop 0
    s_or_b64 s[32:33], s[32:33], vcc
    s_waitcnt vmcnt(0)
    v_cmp_eq_u32 vcc, -1, v96
    s_nop 0
    s_or_b64 s[32:33], s[32:33], vcc
    v_cmp_eq_u32 vcc, -1, v100
    s_nop 0
    s_or_b64 s[32:33], s[32:33], vcc
    v_cmp_eq_u32 vcc, -1, v104
    s_nop 0
    s_or_b64 s[32:33], s[32:33], vcc
    v_cmp_eq_u32 vcc, -1, v108
    s_nop 0
    s_or_b64 s[32:33], s[32:33], vcc
    s_cmp_eq_u64 s[32:33], 0
    s_nop 1
    s_cbranch_scc1 L_b_gathered
    s_mov_b64 exec, 0xffff
L_b_kvprobe:
    global_load_dword v5, v4, s[14:15] sc1
    s_sub_u32 s44, s44, 1
    s_nop 1
    s_cbranch_scc1 L_b_gathered
    s_waitcnt vmcnt(0)
    v_cmp_eq_u32 vcc, -1, v5
    s_nop 0
    s_nop 0
    s_cbranch_vccnz L_b_kvprobe
    s_mov_b64 exec, -1
    s_nop 0
    s_branch L_b_gather
L_b_gathered:
    s_mov_b64 exec, -1
    v_mfma_f32_16x16x32_bf16 v[8:11], v[56:59], v[64:67], 0
    v_mfma_f32_16x16x32_bf16 v[8:11], v[56:59], v[68:71], v[8:11]
    v_mfma_f32_16x16x32_bf16 v[8:11], v[56:59], v[72:75], v[8:11]
    v_mfma_f32_16x16x32_bf16 v[8:11], v[56:59], v[76:79], v[8:11]
    v_mfma_f32_16x16x32_bf16 v[24:27], v[56:59], v[80:83], 0
    v_mfma_f32_16x16x32_bf16 v[24:27], v[56:59], v[84:87], v[24:27]
    v_mfma_f32_16x16x32_bf16 v[24:27], v[56:59], v[88:91], v[24:27]
    v_mfma_f32_16x16x32_bf16 v[24:27], v[56:59], v[92:95], v[24:27]
    v_mfma_f32_16x16x32_bf16 v[44:47], v[56:59], v[96:99], 0
    v_mfma_f32_16x16x32_bf16 v[44:47], v[56:59], v[100:103], v[44:47]
    v_mfma_f32_16x16x32_bf16 v[44:47], v[56:59], v[104:107], v[44:47]
    v_mfma_f32_16x16x32_bf16 v[44:47], v[56:59], v[108:111], v[44:47]
    v_cvt_pk_bf16_f32 v20, v8, v9
    v_cvt_pk_bf16_f32 v21, v10, v11
    ds_write_b64 v51, v[20:21]
    s_nop 0
    v_cvt_pk_bf16_f32 v22, v24, v25
    v_cvt_pk_bf16_f32 v23, v26, v27
    ds_write_b64 v52, v[22:23]
    s_nop 0
    v_cvt_pk_bf16_f32 v12, v44, v45
    v_cvt_pk_bf16_f32 v13, v46, v47
    ds_write_b64 v53, v[12:13]
    ds_write_b64 v54, v[12:13] offset:32
    ds_write_b64 v54, v[12:13] offset:64
    ds_write_b64 v54, v[12:13] offset:96
    s_cmp_lg_u32 s39, 0
    s_nop 0
    s_cbranch_scc1 L_b_cnt2done
    s_mov_b64 exec, 15
    s_mov_b32 s44, 20000
L_b_cnt2:
    v_cmp_gt_u32 vcc, 12, v50
    s_nop 0
    s_nop 0
    s_cbranch_vccz L_b_cnt2done
    global_load_dword v50, v49, s[12:13] offset:4 sc1
    s_waitcnt vmcnt(0)
    s_sub_u32 s44, s44, 1
    s_nop 0
    s_cbranch_scc0 L_b_cnt2
L_b_cnt2done:
    s_mov_b64 exec, -1
    s_waitcnt lgkmcnt(0)
    s_barrier
    s_cmp_lg_u32 s39, 0
    s_nop 0
    s_cbranch_scc1 L_b_wo13
    s_add_u32 s35, s39, 12
    s_min_u32 s35, s35, 12
    s_lshr_b32 s32, s35, 1
    s_add_u32 s32, s32, s26
    s_and_b32 s32, s32, 7
    s_mul_i32 s32, s32, 72
    s_and_b32 s33, s35, 1
    s_lshl_b32 s33, s33, 5
    s_add_u32 s32, s32, s33
    s_add_u32 s32, s32, 8
    s_mul_i32 s32, s32, 1152
    s_mul_i32 s34, s35, 4608
    s_add_u32 s33, s34, 76800
    s_cmp_ge_u32 s35, 6
    s_cselect_b32 s34, s33, s34
    s_add_u32 m0, s34, 0
    s_nop 0
    buffer_load_dwordx4 v29, s[28:31], s32 offen lds
    s_add_u32 m0, s34, 1024
    s_nop 0
    buffer_load_dwordx4 v30, s[28:31], s32 offen lds
    s_add_u32 m0, s34, 2048
    s_nop 0
    buffer_load_dwordx4 v31, s[28:31], s32 offen lds
    s_add_u32 m0, s34, 3072
    s_nop 0
    buffer_load_dwordx4 v32, s[28:31], s32 offen lds
    s_add_u32 m0, s34, 4096
    s_mov_b32 exec_hi, 0
    buffer_load_dwordx4 v33, s[28:31], s32 offen lds
    s_mov_b32 exec_hi, -1
    s_nop 0
    s_branch L_b_wo16
L_b_wo13:
    s_add_u32 s35, s39, 12
    s_lshr_b32 s32, s35, 1
    s_add_u32 s32, s32, s26
    s_and_b32 s32, s32, 7
    s_mul_i32 s32, s32, 72
    s_and_b32 s33, s35, 1
    s_lshl_b32 s33, s33, 5
    s_add_u32 s32, s32, s33
    s_add_u32 s32, s32, 8
    s_mul_i32 s32, s32, 1152
    s_mul_i32 s34, s35, 4608
    s_add_u32 s34, s34, -25088
    s_add_u32 m0, s34, 0
    s_nop 0
    buffer_load_dwordx4 v29, s[28:31], s32 offen lds
    s_add_u32 m0, s34, 1024
    s_nop 0
    buffer_load_dwordx4 v30, s[28:31], s32 offen lds
    s_add_u32 m0, s34, 2048
    s_nop 0
    buffer_load_dwordx4 v31, s[28:31], s32 offen lds
    s_add_u32 m0, s34, 3072
    s_nop 0
    buffer_load_dwordx4 v32, s[28:31], s32 offen lds
    s_add_u32 m0, s34, 4096
    s_mov_b32 exec_hi, 0
    buffer_load_dwordx4 v33, s[28:31], s32 offen lds
    s_mov_b32 exec_hi, -1
L_b_wo16:
    s_cmp_ge_u32 s39, 2
    s_cbranch_scc1 L_b_wodone
    s_mul_i32 s32, s39, 331776
    s_mul_i32 s34, s39, 4608
    s_add_u32 s34, s34, 48640
    s_add_u32 m0, s34, 0
    s_nop 0
    buffer_load_dwordx4 v34, s[28:31], s32 offen lds
    s_add_u32 m0, s34, 1024
    s_nop 0
    buffer_load_dwordx4 v35, s[28:31], s32 offen lds
    s_add_u32 m0, s34, 2048
    s_nop 0
    buffer_load_dwordx4 v36, s[28:31], s32 offen lds
    s_add_u32 m0, s34, 3072
    s_nop 0
    buffer_load_dwordx4 v37, s[28:31], s32 offen lds
    s_add_u32 m0, s34, 4096
    s_mov_b32 exec_hi, 0
    buffer_load_dwordx4 v38, s[28:31], s32 offen lds
    s_mov_b32 exec_hi, -1
L_b_wodone:
    s_waitcnt vmcnt(0)
    s_barrier
    s_endpgm
L_sec_amain:
    s_mul_i32 s33, s24, 4608
    s_add_u32 s33, s33, 100416
    v_lshl_add_u32 v38, v1, 3, s33
    v_mov_b32 v36, 0
    v_mov_b32 v37, 0
    ds_write_b64 v38, v[36:37]
    v_and_b32 v36, 31, v1
    v_lshrrev_b32 v37, 5, v1
    v_mul_u32_u24 v86, 272, v36
    v_lshl_add_u32 v86, v37, 4, v86
    v_add_u32 v86, s27, v86
    v_mov_b32 v96, 0
    v_mov_b32 v97, 0
    v_mov_b32 v98, 0
    v_mov_b32 v99, 0
    v_mov_b32 v100, 0
    v_mov_b32 v101, 0
    v_mov_b32 v102, 0
    v_mov_b32 v103, 0
    v_mov_b32 v104, 0
    v_mov_b32 v105, 0
    v_mov_b32 v106, 0
    v_mov_b32 v107, 0
    v_mov_b32 v108, 0
    v_mov_b32 v109, 0
    v_mov_b32 v110, 0
    v_mov_b32 v111, 0
    v_and_b32 v36, 15, v1
    v_lshrrev_b32 v37, 4, v1
    v_lshlrev_b32 v37, 3, v37
    s_movk_i32 s36, 0x3f80
    v_mov_b32 v38, 0x1ff0
    v_lshlrev_b32 v38, v36, v38
    v_lshrrev_b32 v38, v37, v38
    v_bfe_u32 v39, v38, 0, 1
    v_bfe_u32 v40, v38, 1, 1
    v_lshl_or_b32 v39, v40, 16, v39
    v_mul_u32_u24 v39, s36, v39
    v_accvgpr_write_b32 a136, v39
    v_bfe_u32 v39, v38, 2, 1
    v_bfe_u32 v40, v38, 3, 1
    v_lshl_or_b32 v39, v40, 16, v39
    v_mul_u32_u24 v39, s36, v39
    v_accvgpr_write_b32 a137, v39
    v_bfe_u32 v39, v38, 4, 1
    v_bfe_u32 v40, v38, 5, 1
    v_lshl_or_b32 v39, v40, 16, v39
    v_mul_u32_u24 v39, s36, v39
    v_accvgpr_write_b32 a138, v39
    v_bfe_u32 v39, v38, 6, 1
    v_bfe_u32 v40, v38, 7, 1
    v_lshl_or_b32 v39, v40, 16, v39
    v_mul_u32_u24 v39, s36, v39
    v_accvgpr_write_b32 a139, v39
    v_mov_b32 v38, 0xfe0
    v_lshlrev_b32 v38, v36, v38
    v_lshrrev_b32 v38, v37, v38
    v_bfe_u32 v39, v38, 0, 1
    v_bfe_u32 v40, v38, 1, 1
    v_lshl_or_b32 v39, v40, 16, v39
    v_mul_u32_u24 v39, s36, v39
    v_accvgpr_write_b32 a140, v39
    v_bfe_u32 v39, v38, 2, 1
    v_bfe_u32 v40, v38, 3, 1
    v_lshl_or_b32 v39, v40, 16, v39
    v_mul_u32_u24 v39, s36, v39
    v_accvgpr_write_b32 a141, v39
    v_bfe_u32 v39, v38, 4, 1
    v_bfe_u32 v40, v38, 5, 1
    v_lshl_or_b32 v39, v40, 16, v39
    v_mul_u32_u24 v39, s36, v39
    v_accvgpr_write_b32 a142, v39
    v_bfe_u32 v39, v38, 6, 1
    v_bfe_u32 v40, v38, 7, 1
    v_lshl_or_b32 v39, v40, 16, v39
    v_mul_u32_u24 v39, s36, v39
    v_accvgpr_write_b32 a143, v39
    s_mul_i32 s34, s24, 3584
    s_add_u32 s34, s34, 71744
    v_and_b32 v36, 31, v1
    v_lshrrev_b32 v37, 5, v1
    v_cmp_eq_u32 vcc, 0, v37
    v_lshlrev_b32 v38, 5, v36
    v_lshl_add_u32 v38, v37, 4, v38
    v_add_u32 v87, s34, v38
    v_lshlrev_b32 v39, 4, v36
    v_add_u32 v39, 1024, v39
    v_lshlrev_b32 v40, 3, v36
    v_add_u32 v40, 1536, v40
    v_cndmask_b32 v41, v40, v39, vcc
    v_add_u32 v39, 8, v39
    v_add_u32 v40, 256, v40
    v_cndmask_b32 v42, v40, v39, vcc
    v_add_u32 v88, s34, v41
    v_add_u32 v89, s34, v42
    v_lshlrev_b32 v43, 9, v37
    v_lshl_add_u32 v43, v36, 2, v43
    s_add_u32 s35, s34, 2048
    v_add_u32 v90, s35, v43
    v_lshl_add_u32 v91, v1, 3, s34
    v_lshl_add_u32 v92, v1, 4, s34
    v_cmp_eq_u32 vcc, 0, v1
    s_nop 1
    v_cndmask_b32 v46, 0, -4, vcc
    v_add_u32 v93, v46, v91
    v_subrev_u32 v47, 16, v92
    v_cndmask_b32 v94, v47, v92, vcc
    v_lshlrev_b32 v49, 4, v1
    v_sub_u32 v49, s27, v49
    v_lshlrev_b32 v50, 3, v1
    v_sub_u32 v50, s27, v50
    v_add_u32 v95, 1072, v49
    v_add_u32 v12, 1592, v50
    v_lshlrev_b32 v15, 3, v0
    v_add_u32 v15, 100928, v15
    v_lshlrev_b32 v48, 2, v1
    v_sub_u32 v48, s34, v48
    v_add_u32 v48, 3324, v48
    v_accvgpr_write_b32 a64, v48
    v_and_b32 v36, 7, v1
    v_bfe_u32 v37, v1, 3, 2
    v_mul_u32_u24 v37, 2240, v37
    v_min_u32 v36, 4, v36
    v_lshlrev_b32 v38, 4, v36
    v_cmp_lt_u32 vcc, 2, v36
    v_add_u32 v39, 2064, v38
    s_nop 0
    v_cndmask_b32 v38, v38, v39, vcc
    v_add3_u32 v40, v38, v37, s27
    v_accvgpr_write_b32 a65, v40
    v_and_b32 v36, 3, v1
    v_lshl_add_u32 v40, v36, 4, s34
    v_accvgpr_write_b32 a66, v40
    v_bfe_u32 v37, v1, 2, 2
    v_lshlrev_b32 v38, 1, v36
    v_sub_u32 v38, v37, v38
    v_mul_u32_u24 v37, 2240, v37
    v_lshl_add_u32 v37, v36, 2, v37
    v_add_u32 v37, s27, v37
    v_accvgpr_write_b32 a67, v37
    v_cmp_lt_i32 s[20:21], 0, v38
    v_cmp_lt_i32 s[22:23], 1, v38
    v_cmp_eq_i32 s[58:59], -6, v38
    v_and_b32 v36, 15, v1
    v_lshrrev_b32 v37, 4, v1
    v_and_b32 v38, 3, v36
    v_sub_u32 v39, v36, v38
    v_lshlrev_b32 v39, 1, v39
    v_mul_u32_u24 v38, 2240, v38
    v_lshl_add_u32 v38, v37, 4, v38
    v_sub_u32 v38, v38, v39
    s_add_u32 s35, s27, 24
    v_add_u32 v40, s35, v38
    v_accvgpr_write_b32 a68, v40
    v_lshlrev_b32 v40, 4, v37
    v_lshlrev_b32 v41, 2, v36
    v_sub_u32 v40, v40, v41
    s_add_u32 s35, s34, 3132
    v_add_u32 v40, s35, v40
    v_accvgpr_write_b32 a69, v40
    v_lshlrev_b32 v40, 5, v36
    v_lshl_add_u32 v41, v37, 3, v40
    v_lshl_add_u32 v40, v37, 4, v40
    s_add_u32 s35, s33, 464
    v_add_u32 v40, s35, v40
    v_accvgpr_write_b32 a70, v40
    s_mul_i32 s35, s24, 3072
    s_add_u32 s35, s35, 137280
    v_add_u32 v40, s35, v41
    v_accvgpr_write_b32 a71, v40
    s_add_u32 s35, s33, 512
    v_add_u32 v40, s35, v41
    v_accvgpr_write_b32 a72, v40
    s_waitcnt vmcnt(2)
    v_lshlrev_b32 v8, 16, v8
    v_mul_f32 v8, 0x3fb8aa3b, v8
    v_exp_f32 v8, v8
    v_lshlrev_b32 v9, 16, v9
    v_cvt_pk_bf16_f32 v8, v8, v8
    v_cmp_eq_u32 vcc, 0, v1
    v_lshlrev_b32 v32, 16, v8
    s_nop 0
    v_cndmask_b32 v35, 0, v9, vcc
    v_mul_f32 v33, 0x3fb8aa3b, v32
    v_mul_f32 v34, 0x3e22f983, v32
    s_mov_b32 s32, 2
L_a_pass:
    v_lshlrev_b32 v36, 16, v2
    v_lshlrev_b32 v37, 16, v3
    v_lshlrev_b32 v38, 16, v4
    v_lshlrev_b32 v39, 16, v5
    v_lshlrev_b32 v40, 16, v6
    v_lshlrev_b32 v41, 16, v7
    v_lshrrev_b32 v2, 16, v2
    v_lshrrev_b32 v3, 16, v3
    v_lshrrev_b32 v4, 16, v4
    v_lshrrev_b32 v5, 16, v5
    v_lshrrev_b32 v6, 16, v6
    v_lshrrev_b32 v7, 16, v7
    v_mul_f32 v36, v33, v36
    v_mul_f32 v37, v34, v37
    v_mul_f32 v38, v32, v38
    v_mul_f32 v39, v32, v39
    v_mul_f32 v70, 0x43800000, v36
    v_mul_f32 v71, 0x43800000, v37
    v_mul_f32 v72, 0x41000000, v36
    v_mul_f32 v73, 0x41000000, v37
    v_fract_f32 v71, v71
    v_fract_f32 v37, v37
    v_fract_f32 v73, v73
    v_exp_f32 v70, v70
    v_cos_f32 v48, v71
    v_sin_f32 v49, v71
    v_exp_f32 v36, v36
    v_cos_f32 v44, v37
    v_sin_f32 v45, v37
    v_exp_f32 v72, v72
    v_cos_f32 v46, v73
    v_sin_f32 v47, v73
    v_pk_mul_f32 v[74:75], v[38:39], v[40:41] op_sel_hi:[1,0]
    v_pk_fma_f32 v[42:43], v[38:39], v[40:41], v[74:75] op_sel:[1,1,0] op_sel_hi:[0,1,1] neg_lo:[0,1,0]
    v_mul_f32 v48, v70, v48
    v_mul_f32 v49, v70, v49
    v_mul_f32 v44, v36, v44
    v_mul_f32 v45, v36, v45
    v_mul_f32 v46, v72, v46
    v_mul_f32 v47, v72, v47
    v_cvt_pk_bf16_f32 v79, v42, -v43
    v_pk_mul_f32 v[72:73], v[44:45], v[44:45] op_sel_hi:[1,0]
    v_pk_mul_f32 v[76:77], v[46:47], v[46:47] op_sel_hi:[1,0]
    ds_write_addtid_b32 v79 offset:0
    v_pk_fma_f32 v[60:61], v[44:45], v[44:45], v[72:73] op_sel:[1,1,0] op_sel_hi:[0,1,1] neg_lo:[0,1,0]
    v_pk_fma_f32 v[54:55], v[46:47], v[46:47], v[76:77] op_sel:[1,1,0] op_sel_hi:[0,1,1] neg_lo:[0,1,0]
    v_pk_mul_f32 v[70:71], v[42:43], v[48:49] op_sel_hi:[1,0]
    v_pk_mul_f32 v[74:75], v[42:43], v[44:45] op_sel_hi:[1,0]
    v_pk_mul_f32 v[76:77], v[54:55], v[46:47] op_sel_hi:[1,0]
    v_pk_fma_f32 v[50:51], v[42:43], v[48:49], v[70:71] op_sel:[1,1,0] op_sel_hi:[0,1,1] neg_lo:[0,1,0]
    v_pk_fma_f32 v[68:69], v[42:43], v[44:45], v[74:75] op_sel:[1,1,0] op_sel_hi:[0,1,1] neg_lo:[0,1,0]
    v_pk_fma_f32 v[56:57], v[54:55], v[46:47], v[76:77] op_sel:[1,1,0] op_sel_hi:[0,1,1] neg_lo:[0,1,0]
    v_cvt_pk_bf16_f32 v78, v50, -v51
    v_cvt_pk_bf16_f32 v81, v68, -v69
    v_pk_mul_f32 v[76:77], v[54:55], v[54:55] op_sel_hi:[1,0]
    ds_write_addtid_b32 v78 offset:2176
    ds_write_addtid_b32 v81 offset:272
    v_pk_fma_f32 v[58:59], v[54:55], v[54:55], v[76:77] op_sel:[1,1,0] op_sel_hi:[0,1,1] neg_lo:[0,1,0]
    v_pk_mul_f32 v[70:71], v[50:51], v[48:49] op_sel_hi:[1,0]
    v_pk_mul_f32 v[72:73], v[42:43], v[60:61] op_sel_hi:[1,0]
    v_pk_fma_f32 v[50:51], v[50:51], v[48:49], v[70:71] op_sel:[1,1,0] op_sel_hi:[0,1,1] neg_lo:[0,1,0]
    v_pk_fma_f32 v[62:63], v[42:43], v[60:61], v[72:73] op_sel:[1,1,0] op_sel_hi:[0,1,1] neg_lo:[0,1,0]
    v_cvt_pk_bf16_f32 v79, v50, -v51
    v_cvt_pk_bf16_f32 v80, v62, -v63
    ds_write_addtid_b32 v79 offset:3264
    ds_write_addtid_b32 v80 offset:544
    v_pk_mul_f32 v[70:71], v[50:51], v[48:49] op_sel_hi:[1,0]
    v_pk_mul_f32 v[74:75], v[68:69], v[60:61] op_sel_hi:[1,0]
    v_pk_fma_f32 v[50:51], v[50:51], v[48:49], v[70:71] op_sel:[1,1,0] op_sel_hi:[0,1,1] neg_lo:[0,1,0]
    v_pk_fma_f32 v[68:69], v[68:69], v[60:61], v[74:75] op_sel:[1,1,0] op_sel_hi:[0,1,1] neg_lo:[0,1,0]
    v_cvt_pk_bf16_f32 v78, v50, -v51
    v_cvt_pk_bf16_f32 v81, v68, -v69
    ds_write_addtid_b32 v78 offset:3808
    ds_write_addtid_b32 v81 offset:816
    v_pk_mul_f32 v[70:71], v[50:51], v[48:49] op_sel_hi:[1,0]
    v_pk_mul_f32 v[72:73], v[62:63], v[60:61] op_sel_hi:[1,0]
    v_pk_fma_f32 v[50:51], v[50:51], v[48:49], v[70:71] op_sel:[1,1,0] op_sel_hi:[0,1,1] neg_lo:[0,1,0]
    v_pk_fma_f32 v[64:65], v[62:63], v[60:61], v[72:73] op_sel:[1,1,0] op_sel_hi:[0,1,1] neg_lo:[0,1,0]
    v_cvt_pk_bf16_f32 v79, v50, -v51
    v_cvt_pk_bf16_f32 v80, v64, -v65
    ds_write_addtid_b32 v79 offset:4352
    ds_write_addtid_b32 v80 offset:1088
    v_pk_mul_f32 v[70:71], v[50:51], v[48:49] op_sel_hi:[1,0]
    v_pk_mul_f32 v[74:75], v[68:69], v[60:61] op_sel_hi:[1,0]
    v_pk_fma_f32 v[50:51], v[50:51], v[48:49], v[70:71] op_sel:[1,1,0] op_sel_hi:[0,1,1] neg_lo:[0,1,0]
    v_pk_fma_f32 v[68:69], v[68:69], v[60:61], v[74:75] op_sel:[1,1,0] op_sel_hi:[0,1,1] neg_lo:[0,1,0]
    v_cvt_pk_bf16_f32 v78, v50, -v51
    v_cvt_pk_bf16_f32 v81, v68, -v69
    ds_write_addtid_b32 v78 offset:4624
    ds_write_addtid_b32 v81 offset:1360
    v_pk_mul_f32 v[70:71], v[50:51], v[48:49] op_sel_hi:[1,0]
    v_pk_mul_f32 v[72:73], v[64:65], v[60:61] op_sel_hi:[1,0]
    v_pk_fma_f32 v[50:51], v[50:51], v[48:49], v[70:71] op_sel:[1,1,0] op_sel_hi:[0,1,1] neg_lo:[0,1,0]
    v_pk_fma_f32 v[66:67], v[64:65], v[60:61], v[72:73] op_sel:[1,1,0] op_sel_hi:[0,1,1] neg_lo:[0,1,0]
    v_cvt_pk_bf16_f32 v79, v50, -v51
    v_cvt_pk_bf16_f32 v80, v66, -v67
    ds_write_addtid_b32 v79 offset:4896
    ds_write_addtid_b32 v80 offset:1632
    v_pk_mul_f32 v[70:71], v[50:51], v[48:49] op_sel_hi:[1,0]
    v_pk_mul_f32 v[74:75], v[68:69], v[60:61] op_sel_hi:[1,0]
    v_pk_fma_f32 v[50:51], v[50:51], v[48:49], v[70:71] op_sel:[1,1,0] op_sel_hi:[0,1,1] neg_lo:[0,1,0]
    v_pk_fma_f32 v[68:69], v[68:69], v[60:61], v[74:75] op_sel:[1,1,0] op_sel_hi:[0,1,1] neg_lo:[0,1,0]
    v_cvt_pk_bf16_f32 v78, v50, -v51
    v_cvt_pk_bf16_f32 v81, v68, -v69
    ds_write_addtid_b32 v78 offset:5168
    ds_write_addtid_b32 v81 offset:1904
    v_pk_mul_f32 v[70:71], v[50:51], v[48:49] op_sel_hi:[1,0]
    v_pk_mul_f32 v[72:73], v[64:65], v[48:49] op_sel_hi:[1,0]
    v_pk_fma_f32 v[50:51], v[50:51], v[48:49], v[70:71] op_sel:[1,1,0] op_sel_hi:[0,1,1] neg_lo:[0,1,0]
    v_pk_fma_f32 v[64:65], v[64:65], v[48:49], v[72:73] op_sel:[1,1,0] op_sel_hi:[0,1,1] neg_lo:[0,1,0]
    v_cvt_pk_bf16_f32 v79, v50, -v51
    v_cvt_pk_bf16_f32 v80, v64, -v65
    ds_write_addtid_b32 v79 offset:5440
    ds_write_addtid_b32 v80 offset:2720
    v_pk_mul_f32 v[74:75], v[62:63], v[48:49] op_sel_hi:[1,0]
    v_pk_fma_f32 v[62:63], v[62:63], v[48:49], v[74:75] op_sel:[1,1,0] op_sel_hi:[0,1,1] neg_lo:[0,1,0]
    v_cvt_pk_bf16_f32 v81, v62, -v63
    ds_write_addtid_b32 v81 offset:2448
    v_pk_mul_f32 v[72:73], v[64:65], v[48:49] op_sel_hi:[1,0]
    v_pk_fma_f32 v[64:65], v[64:65], v[48:49], v[72:73] op_sel:[1,1,0] op_sel_hi:[0,1,1] neg_lo:[0,1,0]
    v_cvt_pk_bf16_f32 v80, v64, -v65
    ds_write_addtid_b32 v80 offset:3536
    v_pk_mul_f32 v[74:75], v[66:67], v[48:49] op_sel_hi:[1,0]
    v_pk_fma_f32 v[66:67], v[66:67], v[48:49], v[74:75] op_sel:[1,1,0] op_sel_hi:[0,1,1] neg_lo:[0,1,0]
    v_cvt_pk_bf16_f32 v81, v66, -v67
    ds_write_addtid_b32 v81 offset:2992
    v_pk_mul_f32 v[72:73], v[64:65], v[48:49] op_sel_hi:[1,0]
    v_pk_fma_f32 v[64:65], v[64:65], v[48:49], v[72:73] op_sel:[1,1,0] op_sel_hi:[0,1,1] neg_lo:[0,1,0]
    v_cvt_pk_bf16_f32 v80, v64, -v65
    ds_write_addtid_b32 v80 offset:4080
    s_cmp_lg_u32 s26, 0
    s_cbranch_scc1 L_a_u1_1
    global_load_dwordx4 v[20:23], v13, s[4:5] offset:1152
    s_branch L_a_udone1
L_a_u1_1:
    s_cmp_lg_u32 s26, 1
    s_cbranch_scc1 L_a_u1_2
    global_load_dwordx4 v[24:27], v13, s[4:5] offset:2304
    s_branch L_a_udone1
L_a_u1_2:
    s_cmp_lg_u32 s26, 2
    s_cbranch_scc1 L_a_u1_3
    global_load_dwordx4 v[28:31], v13, s[4:5] offset:3456
    s_branch L_a_udone1
L_a_u1_3:
    global_load_dwordx4 v[16:19], v13, s[4:5] offset:0
L_a_udone1:
    ds_read_b128 a[0:3], v86 offset:0
    ds_read_b128 a[4:7], v86 offset:32
    ds_read_b128 a[8:11], v86 offset:64
    ds_read_b128 a[12:15], v86 offset:96
    ds_read_b128 a[16:19], v86 offset:128
    ds_read_b128 a[20:23], v86 offset:160
    ds_read_b128 a[24:27], v86 offset:192
    ds_read_b128 a[28:31], v86 offset:224
    v_mov_b32 v52, 0x3f80
    ds_write_addtid_b32 v52
    v_cvt_pk_bf16_f32 v78, v46, v47
    ds_write_addtid_b32 v78 offset:272
    v_cvt_pk_bf16_f32 v79, v54, v55
    ds_write_addtid_b32 v79 offset:544
    v_cvt_pk_bf16_f32 v78, v56, v57
    ds_write_addtid_b32 v78 offset:816
    v_cvt_pk_bf16_f32 v79, v58, v59
    ds_write_addtid_b32 v79 offset:1088
    v_pk_mul_f32 v[72:73], v[46:47], v[58:59] op_sel_hi:[1,0]
    v_pk_mul_f32 v[74:75], v[54:55], v[58:59] op_sel_hi:[1,0]
    v_pk_mul_f32 v[76:77], v[56:57], v[58:59] op_sel_hi:[1,0]
    v_pk_mul_f32 v[70:71], v[58:59], v[58:59] op_sel_hi:[1,0]
    v_pk_fma_f32 v[52:53], v[46:47], v[58:59], v[72:73] op_sel:[1,1,0] op_sel_hi:[0,1,1] neg_lo:[0,1,0]
    v_pk_fma_f32 v[54:55], v[54:55], v[58:59], v[74:75] op_sel:[1,1,0] op_sel_hi:[0,1,1] neg_lo:[0,1,0]
    v_pk_fma_f32 v[56:57], v[56:57], v[58:59], v[76:77] op_sel:[1,1,0] op_sel_hi:[0,1,1] neg_lo:[0,1,0]
    v_pk_fma_f32 v[50:51], v[58:59], v[58:59], v[70:71] op_sel:[1,1,0] op_sel_hi:[0,1,1] neg_lo:[0,1,0]
    v_cvt_pk_bf16_f32 v81, v52, v53
    v_cvt_pk_bf16_f32 v83, v54, v55
    v_cvt_pk_bf16_f32 v85, v56, v57
    v_cvt_pk_bf16_f32 v78, v50, v51
    ds_write_addtid_b32 v81 offset:1360
    ds_write_addtid_b32 v83 offset:1632
    ds_write_addtid_b32 v85 offset:1904
    ds_write_addtid_b32 v78 offset:2176
    v_pk_mul_f32 v[72:73], v[52:53], v[58:59] op_sel_hi:[1,0]
    v_pk_mul_f32 v[74:75], v[54:55], v[58:59] op_sel_hi:[1,0]
    v_pk_mul_f32 v[76:77], v[56:57], v[58:59] op_sel_hi:[1,0]
    v_pk_mul_f32 v[70:71], v[50:51], v[58:59] op_sel_hi:[1,0]
    v_pk_fma_f32 v[52:53], v[52:53], v[58:59], v[72:73] op_sel:[1,1,0] op_sel_hi:[0,1,1] neg_lo:[0,1,0]
    v_pk_fma_f32 v[54:55], v[54:55], v[58:59], v[74:75] op_sel:[1,1,0] op_sel_hi:[0,1,1] neg_lo:[0,1,0]
    v_pk_fma_f32 v[56:57], v[56:57], v[58:59], v[76:77] op_sel:[1,1,0] op_sel_hi:[0,1,1] neg_lo:[0,1,0]
    v_pk_fma_f32 v[50:51], v[50:51], v[58:59], v[70:71] op_sel:[1,1,0] op_sel_hi:[0,1,1] neg_lo:[0,1,0]
    v_cvt_pk_bf16_f32 v80, v52, v53
    v_cvt_pk_bf16_f32 v82, v54, v55
    v_cvt_pk_bf16_f32 v84, v56, v57
    v_cvt_pk_bf16_f32 v79, v50, v51
    ds_write_addtid_b32 v80 offset:2448
    ds_write_addtid_b32 v82 offset:2720
    ds_write_addtid_b32 v84 offset:2992
    ds_write_addtid_b32 v79 offset:3264
    v_pk_mul_f32 v[72:73], v[52:53], v[58:59] op_sel_hi:[1,0]
    v_pk_mul_f32 v[74:75], v[54:55], v[58:59] op_sel_hi:[1,0]
    v_pk_mul_f32 v[76:77], v[56:57], v[58:59] op_sel_hi:[1,0]
    v_pk_mul_f32 v[70:71], v[50:51], v[58:59] op_sel_hi:[1,0]
    v_pk_fma_f32 v[52:53], v[52:53], v[58:59], v[72:73] op_sel:[1,1,0] op_sel_hi:[0,1,1] neg_lo:[0,1,0]
    v_pk_fma_f32 v[54:55], v[54:55], v[58:59], v[74:75] op_sel:[1,1,0] op_sel_hi:[0,1,1] neg_lo:[0,1,0]
    v_pk_fma_f32 v[56:57], v[56:57], v[58:59], v[76:77] op_sel:[1,1,0] op_sel_hi:[0,1,1] neg_lo:[0,1,0]
    v_pk_fma_f32 v[50:51], v[50:51], v[58:59], v[70:71] op_sel:[1,1,0] op_sel_hi:[0,1,1] neg_lo:[0,1,0]
    v_cvt_pk_bf16_f32 v81, v52, v53
    v_cvt_pk_bf16_f32 v83, v54, v55
    v_cvt_pk_bf16_f32 v85, v56, v57
    v_cvt_pk_bf16_f32 v78, v50, v51
    ds_write_addtid_b32 v81 offset:3536
    ds_write_addtid_b32 v83 offset:3808
    ds_write_addtid_b32 v85 offset:4080
    ds_write_addtid_b32 v78 offset:4352
    v_pk_mul_f32 v[72:73], v[52:53], v[58:59] op_sel_hi:[1,0]
    v_pk_mul_f32 v[74:75], v[54:55], v[58:59] op_sel_hi:[1,0]
    v_pk_mul_f32 v[76:77], v[56:57], v[58:59] op_sel_hi:[1,0]
    v_pk_mul_f32 v[70:71], v[50:51], v[58:59] op_sel_hi:[1,0]
    v_pk_fma_f32 v[52:53], v[52:53], v[58:59], v[72:73] op_sel:[1,1,0] op_sel_hi:[0,1,1] neg_lo:[0,1,0]
    v_pk_fma_f32 v[54:55], v[54:55], v[58:59], v[74:75] op_sel:[1,1,0] op_sel_hi:[0,1,1] neg_lo:[0,1,0]
    v_pk_fma_f32 v[56:57], v[56:57], v[58:59], v[76:77] op_sel:[1,1,0] op_sel_hi:[0,1,1] neg_lo:[0,1,0]
    v_pk_fma_f32 v[50:51], v[50:51], v[58:59], v[70:71] op_sel:[1,1,0] op_sel_hi:[0,1,1] neg_lo:[0,1,0]
    v_cvt_pk_bf16_f32 v80, v52, v53
    v_cvt_pk_bf16_f32 v82, v54, v55
    v_cvt_pk_bf16_f32 v84, v56, v57
    v_cvt_pk_bf16_f32 v79, v50, v51
    ds_write_addtid_b32 v80 offset:4624
    ds_write_addtid_b32 v82 offset:4896
    ds_write_addtid_b32 v84 offset:5168
    ds_write_addtid_b32 v79 offset:5440
    v_pk_mul_f32 v[72:73], v[52:53], v[58:59] op_sel_hi:[1,0]
    v_pk_mul_f32 v[74:75], v[54:55], v[58:59] op_sel_hi:[1,0]
    v_pk_mul_f32 v[76:77], v[56:57], v[58:59] op_sel_hi:[1,0]
    v_pk_mul_f32 v[70:71], v[50:51], v[58:59] op_sel_hi:[1,0]
    v_pk_fma_f32 v[52:53], v[52:53], v[58:59], v[72:73] op_sel:[1,1,0] op_sel_hi:[0,1,1] neg_lo:[0,1,0]
    v_pk_fma_f32 v[54:55], v[54:55], v[58:59], v[74:75] op_sel:[1,1,0] op_sel_hi:[0,1,1] neg_lo:[0,1,0]
    v_pk_fma_f32 v[56:57], v[56:57], v[58:59], v[76:77] op_sel:[1,1,0] op_sel_hi:[0,1,1] neg_lo:[0,1,0]
    v_pk_fma_f32 v[50:51], v[50:51], v[58:59], v[70:71] op_sel:[1,1,0] op_sel_hi:[0,1,1] neg_lo:[0,1,0]
    v_cvt_pk_bf16_f32 v81, v52, v53
    v_cvt_pk_bf16_f32 v83, v54, v55
    v_cvt_pk_bf16_f32 v85, v56, v57
    v_cvt_pk_bf16_f32 v78, v50, v51
    ds_write_addtid_b32 v81 offset:5712
    ds_write_addtid_b32 v83 offset:5984
    ds_write_addtid_b32 v85 offset:6256
    ds_write_addtid_b32 v78 offset:6528
    v_pk_mul_f32 v[72:73], v[52:53], v[58:59] op_sel_hi:[1,0]
    v_pk_mul_f32 v[74:75], v[54:55], v[58:59] op_sel_hi:[1,0]
    v_pk_mul_f32 v[76:77], v[56:57], v[58:59] op_sel_hi:[1,0]
    v_pk_mul_f32 v[70:71], v[50:51], v[58:59] op_sel_hi:[1,0]
    v_pk_fma_f32 v[52:53], v[52:53], v[58:59], v[72:73] op_sel:[1,1,0] op_sel_hi:[0,1,1] neg_lo:[0,1,0]
    v_pk_fma_f32 v[54:55], v[54:55], v[58:59], v[74:75] op_sel:[1,1,0] op_sel_hi:[0,1,1] neg_lo:[0,1,0]
    v_pk_fma_f32 v[56:57], v[56:57], v[58:59], v[76:77] op_sel:[1,1,0] op_sel_hi:[0,1,1] neg_lo:[0,1,0]
    v_pk_fma_f32 v[50:51], v[50:51], v[58:59], v[70:71] op_sel:[1,1,0] op_sel_hi:[0,1,1] neg_lo:[0,1,0]
    v_cvt_pk_bf16_f32 v80, v52, v53
    v_cvt_pk_bf16_f32 v82, v54, v55
    v_cvt_pk_bf16_f32 v84, v56, v57
    v_cvt_pk_bf16_f32 v79, v50, v51
    ds_write_addtid_b32 v80 offset:6800
    ds_write_addtid_b32 v82 offset:7072
    ds_write_addtid_b32 v84 offset:7344
    ds_write_addtid_b32 v79 offset:7616
    v_pk_mul_f32 v[72:73], v[52:53], v[58:59] op_sel_hi:[1,0]
    v_pk_mul_f32 v[74:75], v[54:55], v[58:59] op_sel_hi:[1,0]
    v_pk_mul_f32 v[76:77], v[56:57], v[58:59] op_sel_hi:[1,0]
    v_pk_fma_f32 v[52:53], v[52:53], v[58:59], v[72:73] op_sel:[1,1,0] op_sel_hi:[0,1,1] neg_lo:[0,1,0]
    v_pk_fma_f32 v[54:55], v[54:55], v[58:59], v[74:75] op_sel:[1,1,0] op_sel_hi:[0,1,1] neg_lo:[0,1,0]
    v_pk_fma_f32 v[56:57], v[56:57], v[58:59], v[76:77] op_sel:[1,1,0] op_sel_hi:[0,1,1] neg_lo:[0,1,0]
    v_cvt_pk_bf16_f32 v81, v52, v53
    v_cvt_pk_bf16_f32 v83, v54, v55
    v_cvt_pk_bf16_f32 v85, v56, v57
    ds_write_addtid_b32 v81 offset:7888
    ds_write_addtid_b32 v83 offset:8160
    ds_write_addtid_b32 v85 offset:8432
    s_cmp_lg_u32 s26, 0
    s_cbranch_scc1 L_a_u0_1
    global_load_dwordx4 v[16:19], v13, s[4:5] offset:0
    s_branch L_a_udone0
L_a_u0_1:
    s_cmp_lg_u32 s26, 1
    s_cbranch_scc1 L_a_u0_2
    global_load_dwordx4 v[20:23], v13, s[4:5] offset:1152
    s_branch L_a_udone0
L_a_u0_2:
    s_cmp_lg_u32 s26, 2
    s_cbranch_scc1 L_a_u0_3
    global_load_dwordx4 v[24:27], v13, s[4:5] offset:2304
    s_branch L_a_udone0
L_a_u0_3:
    global_load_dwordx4 v[28:31], v13, s[4:5] offset:3456
L_a_udone0:
    s_add_u32 s26, s26, 2
    s_and_b32 s26, s26, 3
    ds_read_b128 a[32:35], v86 offset:0
    ds_read_b128 a[36:39], v86 offset:32
    ds_read_b128 a[40:43], v86 offset:64
    ds_read_b128 a[44:47], v86 offset:96
    ds_read_b128 a[48:51], v86 offset:128
    ds_read_b128 a[52:55], v86 offset:160
    ds_read_b128 a[56:59], v86 offset:192
    ds_read_b128 a[60:63], v86 offset:224
    s_waitcnt lgkmcnt(7)
    v_mfma_f32_32x32x16_bf16 v[96:111], a[0:3], a[32:35], v[96:111]
    s_waitcnt lgkmcnt(6)
    v_mfma_f32_32x32x16_bf16 v[96:111], a[4:7], a[36:39], v[96:111]
    s_waitcnt lgkmcnt(5)
    v_mfma_f32_32x32x16_bf16 v[96:111], a[8:11], a[40:43], v[96:111]
    s_waitcnt lgkmcnt(4)
    v_mfma_f32_32x32x16_bf16 v[96:111], a[12:15], a[44:47], v[96:111]
    s_waitcnt lgkmcnt(3)
    v_mfma_f32_32x32x16_bf16 v[96:111], a[16:19], a[48:51], v[96:111]
    s_waitcnt lgkmcnt(2)
    v_mfma_f32_32x32x16_bf16 v[96:111], a[20:23], a[52:55], v[96:111]
    s_waitcnt lgkmcnt(1)
    v_mfma_f32_32x32x16_bf16 v[96:111], a[24:27], a[56:59], v[96:111]
    s_waitcnt lgkmcnt(0)
    v_mfma_f32_32x32x16_bf16 v[96:111], a[28:31], a[60:63], v[96:111]
    s_setprio 0
    s_sub_u32 s32, s32, 1
    s_cmp_lg_u32 s32, 0
    s_cbranch_scc1 L_a_pass
    v_accvgpr_read_b32 v48, a64
    v_accvgpr_read_b32 v36, a65
    v_accvgpr_read_b32 v38, a66
    v_accvgpr_read_b32 v37, a67
    v_cmp_eq_u32 vcc, 0, v1
    v_mov_b32 v51, s34
    v_mov_b32 v76, 0
    v_mov_b32 v77, 0
    v_mov_b32 v78, 0
    v_mov_b32 v79, 0
    ds_write_b128 v87, v[96:99]
    ds_write_b64 v88, v[100:101]
    ds_write_b64 v89, v[102:103]
    ds_write2_b32 v90, v104, v105 offset0:0 offset1:32
    ds_write2_b32 v90, v106, v107 offset0:64 offset1:96
    ds_read_b64 v[56:57], v91 offset:1536
    ds_read_b32 v58, v91 offset:1544
    ds_read_b32 v59, v93 offset:1536
    ds_read_b32 v55, v93 offset:1532
    ds_read_b64 v[60:61], v91 offset:1024
    ds_read_b32 v62, v91 offset:1032
    ds_read_b32 v63, v93 offset:1024
    ds_read2_b32 v[68:69], v93 offset0:254 offset1:255
    ds_read_b128 v[64:67], v92
    ds_read_b128 v[72:75], v94
    ds_read_b32 v52, v91 offset:2052
    ds_read_b32 v53, v91 offset:2056
    ds_read_b32 v70, v51 offset:2044
    ds_read_b32 v71, v51 offset:2048
    ds_write_b128 v36, v[76:79]
    ds_write_b128 v38, v[76:79] offset:3328
    s_waitcnt lgkmcnt(12)
    v_cvt_pk_bf16_f32 v96, v58, v58
    v_cvt_pk_bf16_f32 v97, v57, v57
    v_cvt_pk_bf16_f32 v98, v57, v56
    v_cvt_pk_bf16_f32 v99, v56, v56
    ds_write_b128 v95, v[96:99] offset:6720
    v_cvt_pk_bf16_f32 v100, v58, v57
    v_cvt_pk_bf16_f32 v101, v57, v57
    v_cvt_pk_bf16_f32 v102, v56, v56
    v_cvt_pk_bf16_f32 v103, v56, v56
    ds_write_b128 v95, v[100:103] offset:4480
    v_cvt_pk_bf16_f32 v104, v57, v57
    v_cvt_pk_bf16_f32 v105, v57, v56
    v_cvt_pk_bf16_f32 v106, v56, v56
    v_cvt_pk_bf16_f32 v107, v56, v59
    ds_write_b128 v95, v[104:107] offset:2240
    v_cvt_pk_bf16_f32 v108, v57, v57
    v_cvt_pk_bf16_f32 v109, v56, v56
    v_cvt_pk_bf16_f32 v110, v56, v56
    v_cvt_pk_bf16_f32 v111, v59, v55
    ds_write_b128 v95, v[108:111]
    s_waitcnt lgkmcnt(6)
    v_add_f32 v64, v64, v35
    v_cndmask_b32 v73, v73, v76, vcc
    v_cndmask_b32 v74, v74, v76, vcc
    v_cndmask_b32 v75, v75, v76, vcc
    v_cvt_pk_bf16_f32 v96, v62, v61
    v_cvt_pk_bf16_f32 v97, v60, v60
    ds_write_b64 v12, v[96:97] offset:6720
    v_cvt_pk_bf16_f32 v98, v61, v60
    v_cvt_pk_bf16_f32 v99, v60, v63
    ds_write_b64 v12, v[98:99] offset:4480
    v_cvt_pk_bf16_f32 v100, v60, v60
    v_cvt_pk_bf16_f32 v101, v63, v69
    ds_write_b64 v12, v[100:101] offset:2240
    v_cvt_pk_bf16_f32 v102, v60, v63
    v_cvt_pk_bf16_f32 v103, v69, v68
    ds_write_b64 v12, v[102:103]
    v_cvt_pk_bf16_f32 v104, v67, v66
    v_cvt_pk_bf16_f32 v105, v65, v64
    ds_write_b64 v12, v[104:105] offset:7232
    v_cvt_pk_bf16_f32 v106, v66, v65
    v_cvt_pk_bf16_f32 v107, v64, v75
    ds_write_b64 v12, v[106:107] offset:4992
    v_cvt_pk_bf16_f32 v108, v65, v64
    v_cvt_pk_bf16_f32 v109, v75, v74
    ds_write_b64 v12, v[108:109] offset:2752
    v_cvt_pk_bf16_f32 v110, v64, v75
    v_cvt_pk_bf16_f32 v111, v74, v73
    ds_write_b64 v12, v[110:111] offset:512
    v_cvt_pk_bf16_f32 v54, v53, v52
    ds_write_b32 v48, v54
    v_cndmask_b32 v39, v71, v76, s[20:21]
    v_cndmask_b32 v40, v71, v76, s[22:23]
    v_cndmask_b32 v40, v40, v70, s[58:59]
    v_cvt_pk_bf16_f32 v39, v39, v40
    ds_write_b32 v37, v39 offset:48
    v_accvgpr_read_b32 v2, a68
    v_accvgpr_read_b32 v3, a69
    v_accvgpr_read_b32 v4, a70
    v_accvgpr_read_b32 v7, a71
    v_accvgpr_read_b32 v6, a72
    v_add_u32 v5, 16, v4
    v_mov_b32 v64, 0
    v_mov_b32 v65, 0
    v_mov_b32 v66, 0
    v_mov_b32 v67, 0
    v_mov_b32 v68, 0
    v_mov_b32 v69, 0
    v_mov_b32 v70, 0
    v_mov_b32 v71, 0
    v_mov_b32 v72, 0
    v_mov_b32 v73, 0
    v_mov_b32 v74, 0
    v_mov_b32 v75, 0
    v_mov_b32 v76, 0
    v_mov_b32 v77, 0
    v_mov_b32 v78, 0
    v_mov_b32 v79, 0
    ds_read2_b32 a[96:97], v3 offset0:48 offset1:49
    ds_read2_b32 a[98:99], v3 offset0:50 offset1:51
    ds_read2_b32 a[100:101], v3 offset0:32 offset1:33
    ds_read2_b32 a[102:103], v3 offset0:34 offset1:35
    ds_read2_b32 a[104:105], v3 offset0:16 offset1:17
    ds_read2_b32 a[106:107], v3 offset0:18 offset1:19
    ds_read2_b32 a[108:109], v3 offset0:0 offset1:1
    ds_read2_b32 a[110:111], v3 offset0:2 offset1:3
    ds_read_b64 a[128:129], v2
    ds_read_b64 a[130:131], v2 offset:8
    s_waitcnt vmcnt(0)
    v_perm_b32 v36, v20, v16, s30
    v_perm_b32 v37, v28, v24, s30
    ds_write_b64 v15, v[36:37] offset:0
    v_perm_b32 v38, v20, v16, s31
    v_perm_b32 v39, v28, v24, s31
    ds_write_b64 v15, v[38:39] offset:4608
    v_perm_b32 v40, v21, v17, s30
    v_perm_b32 v41, v29, v25, s30
    ds_write_b64 v15, v[40:41] offset:9216
    v_perm_b32 v42, v21, v17, s31
    v_perm_b32 v43, v29, v25, s31
    ds_write_b64 v15, v[42:43] offset:13824
    v_perm_b32 v44, v22, v18, s30
    v_perm_b32 v45, v30, v26, s30
    ds_write_b64 v15, v[44:45] offset:18432
    v_perm_b32 v46, v22, v18, s31
    v_perm_b32 v47, v30, v26, s31
    ds_write_b64 v15, v[46:47] offset:23040
    v_perm_b32 v48, v23, v19, s30
    v_perm_b32 v49, v31, v27, s30
    ds_write_b64 v15, v[48:49] offset:27648
    v_perm_b32 v50, v23, v19, s31
    v_perm_b32 v51, v31, v27, s31
    ds_write_b64 v15, v[50:51] offset:32256
    s_waitcnt lgkmcnt(0)
    s_barrier
    ds_read_b128 a[64:67], v4 offset:0
    ds_read_b128 a[68:71], v5 offset:0
    ds_read_b128 a[72:75], v4 offset:512
    ds_read_b128 a[76:79], v5 offset:512
    ds_read_b128 a[80:83], v4 offset:1024
    ds_read_b128 a[84:87], v5 offset:1024
    ds_read_b128 a[88:91], v4 offset:1536
    ds_read_b128 a[92:95], v5 offset:1536
    s_waitcnt lgkmcnt(6)
    v_mfma_f32_16x16x32_bf16 v[24:27], a[64:67], a[136:139], 0
    v_mfma_f32_16x16x32_bf16 v[28:31], a[68:71], a[140:143], 0
    v_mfma_f32_16x16x32_bf16 v[80:83], a[128:131], a[68:71], 0
    s_waitcnt lgkmcnt(4)
    v_mfma_f32_16x16x32_bf16 v[32:35], a[72:75], a[136:139], 0
    v_mfma_f32_16x16x32_bf16 v[36:39], a[76:79], a[140:143], 0
    v_mfma_f32_16x16x32_bf16 v[84:87], a[128:131], a[76:79], 0
    s_nop 2
    v_cvt_pk_bf16_f32 v24, v24, v28
    v_cvt_pk_bf16_f32 v25, v25, v29
    v_cvt_pk_bf16_f32 v26, v26, v30
    v_cvt_pk_bf16_f32 v27, v27, v31
    s_waitcnt lgkmcnt(2)
    v_mfma_f32_16x16x32_bf16 v[40:43], a[80:83], a[136:139], 0
    v_mfma_f32_16x16x32_bf16 v[44:47], a[84:87], a[140:143], 0
    v_mfma_f32_16x16x32_bf16 v[88:91], a[128:131], a[84:87], 0
    v_cvt_pk_bf16_f32 v32, v32, v36
    v_cvt_pk_bf16_f32 v33, v33, v37
    v_cvt_pk_bf16_f32 v34, v34, v38
    v_cvt_pk_bf16_f32 v35, v35, v39
    s_waitcnt lgkmcnt(0)
    v_mfma_f32_16x16x32_bf16 v[48:51], a[88:91], a[136:139], 0
    v_mfma_f32_16x16x32_bf16 v[52:55], a[92:95], a[140:143], 0
    v_mfma_f32_16x16x32_bf16 v[92:95], a[128:131], a[92:95], 0
    v_cvt_pk_bf16_f32 v40, v40, v44
    v_cvt_pk_bf16_f32 v41, v41, v45
    v_cvt_pk_bf16_f32 v42, v42, v46
    v_cvt_pk_bf16_f32 v43, v43, v47
    v_mfma_f32_16x16x32_bf16 v[80:83], v[24:27], a[96:99], v[80:83]
    ds_read_b64 a[0:1], v2 offset:2048
    ds_read_b64 a[2:3], v2 offset:2056
    v_mfma_f32_16x16x32_bf16 v[84:87], v[24:27], a[100:103], v[84:87]
    ds_read_b128 a[16:19], v5 offset:0
    ds_read_b128 a[20:23], v5 offset:512
    v_mfma_f32_16x16x32_bf16 v[88:91], v[24:27], a[104:107], v[88:91]
    ds_read_b128 a[24:27], v5 offset:1024
    ds_read_b128 a[28:31], v5 offset:1536
    v_mfma_f32_16x16x32_bf16 v[92:95], v[24:27], a[108:111], v[92:95]
    ds_read_b128 a[32:35], v5 offset:2048
    ds_read_b64 a[4:5], v2 offset:1536
    v_cvt_pk_bf16_f32 v48, v48, v52
    v_cvt_pk_bf16_f32 v49, v49, v53
    v_cvt_pk_bf16_f32 v50, v50, v54
    v_cvt_pk_bf16_f32 v51, v51, v55
    v_mfma_f32_16x16x32_bf16 v[84:87], v[32:35], a[96:99], v[84:87]
    ds_read_b64 a[6:7], v2 offset:1544
    ds_read_b64 a[8:9], v2 offset:1024
    v_mfma_f32_16x16x32_bf16 v[88:91], v[32:35], a[100:103], v[88:91]
    ds_read_b64 a[10:11], v2 offset:1032
    ds_read_b64 a[12:13], v2 offset:512
    v_mfma_f32_16x16x32_bf16 v[92:95], v[32:35], a[104:107], v[92:95]
    ds_read_b64 a[14:15], v2 offset:520
    v_subrev_u32 v2, 64, v2
    v_mfma_f32_16x16x32_bf16 v[88:91], v[40:43], a[96:99], v[88:91]
    v_subrev_u32 v5, 64, v5
    v_mfma_f32_16x16x32_bf16 v[92:95], v[40:43], a[100:103], v[92:95]
    v_mfma_f32_16x16x32_bf16 v[92:95], v[48:51], a[96:99], v[92:95]
    s_mov_b32 s32, 3
L_a_conva:
    s_waitcnt lgkmcnt(4)
    v_mfma_f32_16x16x32_bf16 v[64:67], a[0:3], a[16:19], v[64:67]
    ds_read_b64 a[48:49], v2 offset:2048
    ds_read_b64 a[50:51], v2 offset:2056
    v_mfma_f32_16x16x32_bf16 v[68:71], a[0:3], a[20:23], v[68:71]
    ds_read_b128 a[64:67], v5 offset:0
    v_mfma_f32_16x16x32_bf16 v[72:75], a[0:3], a[24:27], v[72:75]
    ds_read_b128 a[68:71], v5 offset:512
    v_mfma_f32_16x16x32_bf16 v[76:79], a[0:3], a[28:31], v[76:79]
    ds_read_b128 a[72:75], v5 offset:1024
    v_mfma_f32_16x16x32_bf16 v[80:83], a[0:3], a[32:35], v[80:83]
    ds_read_b128 a[76:79], v5 offset:1536
    v_mfma_f32_16x16x32_bf16 v[68:71], a[4:7], a[16:19], v[68:71]
    ds_read_b128 a[80:83], v5 offset:2048
    v_mfma_f32_16x16x32_bf16 v[72:75], a[4:7], a[20:23], v[72:75]
    ds_read_b64 a[52:53], v2 offset:1536
    v_mfma_f32_16x16x32_bf16 v[76:79], a[4:7], a[24:27], v[76:79]
    ds_read_b64 a[54:55], v2 offset:1544
    v_mfma_f32_16x16x32_bf16 v[80:83], a[4:7], a[28:31], v[80:83]
    ds_read_b64 a[56:57], v2 offset:1024
    s_waitcnt lgkmcnt(10)
    v_mfma_f32_16x16x32_bf16 v[72:75], a[8:11], a[16:19], v[72:75]
    ds_read_b64 a[58:59], v2 offset:1032
    v_mfma_f32_16x16x32_bf16 v[76:79], a[8:11], a[20:23], v[76:79]
    ds_read_b64 a[60:61], v2 offset:512
    v_mfma_f32_16x16x32_bf16 v[80:83], a[8:11], a[24:27], v[80:83]
    ds_read_b64 a[62:63], v2 offset:520
    v_mfma_f32_16x16x32_bf16 v[76:79], a[12:15], a[16:19], v[76:79]
    v_subrev_u32 v2, 64, v2
    v_mfma_f32_16x16x32_bf16 v[80:83], a[12:15], a[20:23], v[80:83]
    v_subrev_u32 v5, 64, v5
    s_waitcnt lgkmcnt(4)
    v_mfma_f32_16x16x32_bf16 v[64:67], a[48:51], a[64:67], v[64:67]
    ds_read_b64 a[0:1], v2 offset:2048
    ds_read_b64 a[2:3], v2 offset:2056
    v_mfma_f32_16x16x32_bf16 v[68:71], a[48:51], a[68:71], v[68:71]
    ds_read_b128 a[16:19], v5 offset:0
    v_mfma_f32_16x16x32_bf16 v[72:75], a[48:51], a[72:75], v[72:75]
    ds_read_b128 a[20:23], v5 offset:512
    v_mfma_f32_16x16x32_bf16 v[76:79], a[48:51], a[76:79], v[76:79]
    ds_read_b128 a[24:27], v5 offset:1024
    v_mfma_f32_16x16x32_bf16 v[80:83], a[48:51], a[80:83], v[80:83]
    ds_read_b128 a[28:31], v5 offset:1536
    v_mfma_f32_16x16x32_bf16 v[68:71], a[52:55], a[64:67], v[68:71]
    ds_read_b128 a[32:35], v5 offset:2048
    v_mfma_f32_16x16x32_bf16 v[72:75], a[52:55], a[68:71], v[72:75]
    ds_read_b64 a[4:5], v2 offset:1536
    v_mfma_f32_16x16x32_bf16 v[76:79], a[52:55], a[72:75], v[76:79]
    ds_read_b64 a[6:7], v2 offset:1544
    v_mfma_f32_16x16x32_bf16 v[80:83], a[52:55], a[76:79], v[80:83]
    ds_read_b64 a[8:9], v2 offset:1024
    s_waitcnt lgkmcnt(10)
    v_mfma_f32_16x16x32_bf16 v[72:75], a[56:59], a[64:67], v[72:75]
    ds_read_b64 a[10:11], v2 offset:1032
    v_mfma_f32_16x16x32_bf16 v[76:79], a[56:59], a[68:71], v[76:79]
    ds_read_b64 a[12:13], v2 offset:512
    v_mfma_f32_16x16x32_bf16 v[80:83], a[56:59], a[72:75], v[80:83]
    ds_read_b64 a[14:15], v2 offset:520
    v_mfma_f32_16x16x32_bf16 v[76:79], a[60:63], a[64:67], v[76:79]
    v_subrev_u32 v2, 64, v2
    v_mfma_f32_16x16x32_bf16 v[80:83], a[60:63], a[68:71], v[80:83]
    v_subrev_u32 v5, 64, v5
    s_sub_u32 s32, s32, 1
    s_cmp_lg_u32 s32, 0
    s_cbranch_scc1 L_a_conva
    s_waitcnt lgkmcnt(4)
    v_mfma_f32_16x16x32_bf16 v[64:67], a[0:3], a[16:19], v[64:67]
    ds_read_b64 a[48:49], v2 offset:2048
    ds_read_b64 a[50:51], v2 offset:2056
    v_mfma_f32_16x16x32_bf16 v[68:71], a[0:3], a[20:23], v[68:71]
    ds_read_b128 a[64:67], v5 offset:0
    v_mfma_f32_16x16x32_bf16 v[72:75], a[0:3], a[24:27], v[72:75]
    ds_read_b128 a[68:71], v5 offset:512
    v_mfma_f32_16x16x32_bf16 v[76:79], a[0:3], a[28:31], v[76:79]
    ds_read_b128 a[72:75], v5 offset:1024
    v_mfma_f32_16x16x32_bf16 v[80:83], a[0:3], a[32:35], v[80:83]
    ds_read_b128 a[76:79], v5 offset:1536
    v_mfma_f32_16x16x32_bf16 v[68:71], a[4:7], a[16:19], v[68:71]
    ds_read_b128 a[80:83], v5 offset:2048
    v_mfma_f32_16x16x32_bf16 v[72:75], a[4:7], a[20:23], v[72:75]
    ds_read_b64 a[52:53], v2 offset:1536
    v_mfma_f32_16x16x32_bf16 v[76:79], a[4:7], a[24:27], v[76:79]
    ds_read_b64 a[54:55], v2 offset:1544
    v_mfma_f32_16x16x32_bf16 v[80:83], a[4:7], a[28:31], v[80:83]
    ds_read_b64 a[56:57], v2 offset:1024
    s_waitcnt lgkmcnt(10)
    v_mfma_f32_16x16x32_bf16 v[72:75], a[8:11], a[16:19], v[72:75]
    ds_read_b64 a[58:59], v2 offset:1032
    v_mfma_f32_16x16x32_bf16 v[76:79], a[8:11], a[20:23], v[76:79]
    ds_read_b64 a[60:61], v2 offset:512
    v_mfma_f32_16x16x32_bf16 v[80:83], a[8:11], a[24:27], v[80:83]
    ds_read_b64 a[62:63], v2 offset:520
    v_mfma_f32_16x16x32_bf16 v[76:79], a[12:15], a[16:19], v[76:79]
    v_subrev_u32 v2, 64, v2
    v_mfma_f32_16x16x32_bf16 v[80:83], a[12:15], a[20:23], v[80:83]
    v_subrev_u32 v5, 64, v5
    v_add_u32 v2, 512, v2
    v_add_u32 v5, 512, v5
    s_waitcnt lgkmcnt(4)
    v_mfma_f32_16x16x32_bf16 v[64:67], a[48:51], a[64:67], v[64:67]
    ds_read_b64 a[0:1], v2 offset:2048
    ds_read_b64 a[2:3], v2 offset:2056
    v_mfma_f32_16x16x32_bf16 v[68:71], a[48:51], a[68:71], v[68:71]
    ds_read_b128 a[28:31], v5 offset:2560
    ds_read_b128 a[32:35], v5 offset:3072
    v_mfma_f32_16x16x32_bf16 v[72:75], a[48:51], a[72:75], v[72:75]
    ds_read_b128 a[36:39], v5 offset:3584
    v_mfma_f32_16x16x32_bf16 v[76:79], a[48:51], a[76:79], v[76:79]
    ds_read_b64 a[4:5], v2 offset:1536
    v_mfma_f32_16x16x32_bf16 v[80:83], a[48:51], a[80:83], v[80:83]
    ds_read_b64 a[6:7], v2 offset:1544
    v_mfma_f32_16x16x32_bf16 v[68:71], a[52:55], a[64:67], v[68:71]
    ds_read_b128 a[24:27], v5 offset:2048
    v_mfma_f32_16x16x32_bf16 v[72:75], a[52:55], a[68:71], v[72:75]
    ds_read_b64 a[8:9], v2 offset:1024
    v_mfma_f32_16x16x32_bf16 v[76:79], a[52:55], a[72:75], v[76:79]
    ds_read_b64 a[10:11], v2 offset:1032
    v_mfma_f32_16x16x32_bf16 v[80:83], a[52:55], a[76:79], v[80:83]
    ds_read_b128 a[20:23], v5 offset:1536
    s_waitcnt lgkmcnt(11)
    v_mfma_f32_16x16x32_bf16 v[72:75], a[56:59], a[64:67], v[72:75]
    ds_read_b64 a[12:13], v2 offset:512
    v_mfma_f32_16x16x32_bf16 v[76:79], a[56:59], a[68:71], v[76:79]
    ds_read_b64 a[14:15], v2 offset:520
    v_mfma_f32_16x16x32_bf16 v[80:83], a[56:59], a[72:75], v[80:83]
    ds_read_b128 a[16:19], v5 offset:1024
    v_mfma_f32_16x16x32_bf16 v[76:79], a[60:63], a[64:67], v[76:79]
    v_subrev_u32 v2, 64, v2
    v_mfma_f32_16x16x32_bf16 v[80:83], a[60:63], a[68:71], v[80:83]
    v_subrev_u32 v5, 64, v5
    s_waitcnt lgkmcnt(6)
    v_mfma_f32_16x16x32_bf16 v[84:87], a[0:3], a[28:31], v[84:87]
    ds_read_b64 a[48:49], v2 offset:2048
    v_cvt_pk_bf16_f32 v36, v64, v65
    ds_read_b64 a[50:51], v2 offset:2056
    v_mfma_f32_16x16x32_bf16 v[88:91], a[0:3], a[32:35], v[88:91]
    v_cvt_pk_bf16_f32 v37, v66, v67
    ds_read_b128 a[76:79], v5 offset:2560
    v_mfma_f32_16x16x32_bf16 v[92:95], a[0:3], a[36:39], v[92:95]
    ds_write_b64 v7, v[36:37] offset:0
    ds_read_b128 a[80:83], v5 offset:3072
    v_mfma_f32_16x16x32_bf16 v[84:87], a[4:7], a[24:27], v[84:87]
    v_cvt_pk_bf16_f32 v38, v68, v69
    ds_read_b128 a[84:87], v5 offset:3584
    v_mfma_f32_16x16x32_bf16 v[88:91], a[4:7], a[28:31], v[88:91]
    v_cvt_pk_bf16_f32 v39, v70, v71
    ds_read_b64 a[52:53], v2 offset:1536
    v_mfma_f32_16x16x32_bf16 v[92:95], a[4:7], a[32:35], v[92:95]
    ds_write_b64 v7, v[38:39] offset:512
    ds_read_b64 a[54:55], v2 offset:1544
    s_waitcnt lgkmcnt(9)
    v_mfma_f32_16x16x32_bf16 v[84:87], a[8:11], a[20:23], v[84:87]
    v_cvt_pk_bf16_f32 v40, v72, v73
    ds_read_b128 a[72:75], v5 offset:2048
    v_mfma_f32_16x16x32_bf16 v[88:91], a[8:11], a[24:27], v[88:91]
    v_cvt_pk_bf16_f32 v41, v74, v75
    ds_read_b64 a[56:57], v2 offset:1024
    v_mfma_f32_16x16x32_bf16 v[92:95], a[8:11], a[28:31], v[92:95]
    ds_write_b64 v7, v[40:41] offset:1024
    ds_read_b64 a[58:59], v2 offset:1032
    v_mfma_f32_16x16x32_bf16 v[84:87], a[12:15], a[16:19], v[84:87]
    ds_read_b128 a[68:71], v5 offset:1536
    ds_read_b64 a[60:61], v2 offset:512
    v_mfma_f32_16x16x32_bf16 v[88:91], a[12:15], a[20:23], v[88:91]
    ds_read_b64 a[62:63], v2 offset:520
    ds_read_b128 a[64:67], v5 offset:1024
    v_mfma_f32_16x16x32_bf16 v[92:95], a[12:15], a[24:27], v[92:95]
    v_subrev_u32 v2, 64, v2
    v_subrev_u32 v5, 64, v5
    s_waitcnt lgkmcnt(7)
    v_mfma_f32_16x16x32_bf16 v[84:87], a[48:51], a[76:79], v[84:87]
    ds_read_b64 a[0:1], v2 offset:2048
    v_cvt_pk_bf16_f32 v42, v76, v77
    v_mfma_f32_16x16x32_bf16 v[88:91], a[48:51], a[80:83], v[88:91]
    ds_read_b64 a[2:3], v2 offset:2056
    v_cvt_pk_bf16_f32 v43, v78, v79
    v_mfma_f32_16x16x32_bf16 v[92:95], a[48:51], a[84:87], v[92:95]
    ds_read_b128 a[28:31], v5 offset:2560
    ds_write_b64 v7, v[42:43] offset:1536
    v_mfma_f32_16x16x32_bf16 v[84:87], a[52:55], a[72:75], v[84:87]
    ds_read_b128 a[32:35], v5 offset:3072
    v_cvt_pk_bf16_f32 v44, v80, v81
    v_mfma_f32_16x16x32_bf16 v[88:91], a[52:55], a[76:79], v[88:91]
    ds_read_b128 a[36:39], v5 offset:3584
    v_cvt_pk_bf16_f32 v45, v82, v83
    v_mfma_f32_16x16x32_bf16 v[92:95], a[52:55], a[80:83], v[92:95]
    ds_read_b64 a[4:5], v2 offset:1536
    ds_write_b64 v7, v[44:45] offset:2048
    s_waitcnt lgkmcnt(8)
    v_mfma_f32_16x16x32_bf16 v[84:87], a[56:59], a[68:71], v[84:87]
    ds_read_b64 a[6:7], v2 offset:1544
    v_lshlrev_b32 v23, 2, v0
    v_mfma_f32_16x16x32_bf16 v[88:91], a[56:59], a[72:75], v[88:91]
    ds_read_b128 a[24:27], v5 offset:2048
    v_add_u32 v23, 100416, v23
    v_mfma_f32_16x16x32_bf16 v[92:95], a[56:59], a[76:79], v[92:95]
    ds_read_b64 a[8:9], v2 offset:1024
    ds_read_b64 a[10:11], v2 offset:1032
    v_mfma_f32_16x16x32_bf16 v[84:87], a[60:63], a[64:67], v[84:87]
    ds_read_b128 a[20:23], v5 offset:1536
    ds_read_b64 a[12:13], v2 offset:512
    v_mfma_f32_16x16x32_bf16 v[88:91], a[60:63], a[68:71], v[88:91]
    ds_read_b64 a[14:15], v2 offset:520
    ds_read_b128 a[16:19], v5 offset:1024
    v_mfma_f32_16x16x32_bf16 v[92:95], a[60:63], a[72:75], v[92:95]
    v_subrev_u32 v2, 64, v2
    v_subrev_u32 v5, 64, v5
    s_waitcnt lgkmcnt(0)
    s_barrier
    s_cmp_ge_u32 s24, 4
    s_cbranch_scc1 L_a_nosend
    v_lshlrev_b32 v13, 3, v0
    v_add_u32 v13, 137280, v13
    ds_read_b64 v[96:97], v13 offset:0
    ds_read_b64 v[98:99], v13 offset:3072
    ds_read_b64 v[100:101], v13 offset:6144
    ds_read_b64 v[102:103], v13 offset:9216
    ds_read_b64 v[104:105], v13 offset:12288
    ds_read_b64 v[106:107], v13 offset:15360
    ds_read_b64 v[108:109], v13 offset:18432
    ds_read_b64 v[110:111], v13 offset:21504
    v_lshlrev_b32 v13, 1, v0
    v_add_u32 v13, 139328, v13
    ds_read_u16 v24, v13 offset:0
    ds_read_u16 v25, v13 offset:3072
    ds_read_u16 v26, v13 offset:6144
    ds_read_u16 v27, v13 offset:9216
    ds_read_u16 v28, v13 offset:12288
    ds_read_u16 v29, v13 offset:15360
    ds_read_u16 v30, v13 offset:18432
    ds_read_u16 v31, v13 offset:21504
    s_lshl_b32 s35, s25, 4
    v_mul_u32_u24 v12, 9216, v0
    v_add_u32 v12, s35, v12
    v_add_u32 v15, 4608, v12
    s_add_u32 s35, s35, 2359296
    v_mul_u32_u24 v13, 2304, v0
    s_waitcnt lgkmcnt(8)
    v_add_u32 v13, s35, v13
    v_perm_b32 v36, v98, v96, s30
    v_perm_b32 v37, v102, v100, s30
    v_perm_b32 v38, v106, v104, s30
    v_perm_b32 v39, v110, v108, s30
    v_perm_b32 v40, v98, v96, s31
    v_perm_b32 v41, v102, v100, s31
    v_perm_b32 v42, v106, v104, s31
    v_perm_b32 v43, v110, v108, s31
    v_perm_b32 v44, v99, v97, s30
    v_perm_b32 v45, v103, v101, s30
    v_perm_b32 v46, v107, v105, s30
    v_perm_b32 v47, v111, v109, s30
    v_perm_b32 v48, v99, v97, s31
    v_perm_b32 v49, v103, v101, s31
    v_perm_b32 v50, v107, v105, s31
    v_perm_b32 v51, v111, v109, s31
    s_waitcnt lgkmcnt(0)
    v_perm_b32 v52, v25, v24, s30
    v_perm_b32 v53, v27, v26, s30
    v_perm_b32 v54, v29, v28, s30
    v_perm_b32 v55, v31, v30, s30
    global_store_dwordx4 v12, v[36:39], s[52:53] offset:0
L_a_nosend:
    s_mov_b32 s32, 3
L_a_convb:
    s_cmp_ge_u32 s24, 4
    s_cbranch_scc1 L_a_trd1
    s_cmp_lg_u32 s32, 3
    s_cbranch_scc1 L_a_tr1_0
    global_store_dwordx4 v12, v[40:43], s[52:53] offset:2304
L_a_tr1_0:
    s_cmp_lg_u32 s32, 2
    s_cbranch_scc1 L_a_tr1_1
    global_store_dwordx4 v15, v[48:51], s[52:53] offset:2304
L_a_tr1_1:
L_a_trd1:
    s_waitcnt lgkmcnt(6)
    v_mfma_f32_16x16x32_bf16 v[84:87], a[0:3], a[28:31], v[84:87]
    ds_read_b64 a[48:49], v2 offset:2048
    ds_read_b64 a[50:51], v2 offset:2056
    v_mfma_f32_16x16x32_bf16 v[88:91], a[0:3], a[32:35], v[88:91]
    ds_read_b128 a[76:79], v5 offset:2560
    ds_read_b128 a[80:83], v5 offset:3072
    v_mfma_f32_16x16x32_bf16 v[92:95], a[0:3], a[36:39], v[92:95]
    ds_read_b128 a[84:87], v5 offset:3584
    ds_read_b64 a[52:53], v2 offset:1536
    v_mfma_f32_16x16x32_bf16 v[84:87], a[4:7], a[24:27], v[84:87]
    ds_read_b64 a[54:55], v2 offset:1544
    ds_read_b128 a[72:75], v5 offset:2048
    v_mfma_f32_16x16x32_bf16 v[88:91], a[4:7], a[28:31], v[88:91]
    ds_read_b64 a[56:57], v2 offset:1024
    v_mfma_f32_16x16x32_bf16 v[92:95], a[4:7], a[32:35], v[92:95]
    ds_read_b64 a[58:59], v2 offset:1032
    s_waitcnt lgkmcnt(10)
    v_mfma_f32_16x16x32_bf16 v[84:87], a[8:11], a[20:23], v[84:87]
    ds_read_b128 a[68:71], v5 offset:1536
    v_mfma_f32_16x16x32_bf16 v[88:91], a[8:11], a[24:27], v[88:91]
    ds_read_b64 a[60:61], v2 offset:512
    v_mfma_f32_16x16x32_bf16 v[92:95], a[8:11], a[28:31], v[92:95]
    ds_read_b64 a[62:63], v2 offset:520
    v_mfma_f32_16x16x32_bf16 v[84:87], a[12:15], a[16:19], v[84:87]
    ds_read_b128 a[64:67], v5 offset:1024
    v_mfma_f32_16x16x32_bf16 v[88:91], a[12:15], a[20:23], v[88:91]
    v_subrev_u32 v2, 64, v2
    v_mfma_f32_16x16x32_bf16 v[92:95], a[12:15], a[24:27], v[92:95]
    v_subrev_u32 v5, 64, v5
    s_cmp_ge_u32 s24, 4
    s_cbranch_scc1 L_a_trd2
    s_cmp_lg_u32 s32, 3
    s_cbranch_scc1 L_a_tr2_0
    global_store_dwordx4 v15, v[44:47], s[52:53] offset:0
L_a_tr2_0:
    s_cmp_lg_u32 s32, 2
    s_cbranch_scc1 L_a_tr2_1
    global_store_dwordx4 v13, v[52:55], s[52:53]
L_a_tr2_1:
L_a_trd2:
    s_waitcnt lgkmcnt(6)
    v_mfma_f32_16x16x32_bf16 v[84:87], a[48:51], a[76:79], v[84:87]
    ds_read_b64 a[0:1], v2 offset:2048
    ds_read_b64 a[2:3], v2 offset:2056
    v_mfma_f32_16x16x32_bf16 v[88:91], a[48:51], a[80:83], v[88:91]
    ds_read_b128 a[28:31], v5 offset:2560
    ds_read_b128 a[32:35], v5 offset:3072
    v_mfma_f32_16x16x32_bf16 v[92:95], a[48:51], a[84:87], v[92:95]
    ds_read_b128 a[36:39], v5 offset:3584
    ds_read_b64 a[4:5], v2 offset:1536
    v_mfma_f32_16x16x32_bf16 v[84:87], a[52:55], a[72:75], v[84:87]
    ds_read_b64 a[6:7], v2 offset:1544
    ds_read_b128 a[24:27], v5 offset:2048
    v_mfma_f32_16x16x32_bf16 v[88:91], a[52:55], a[76:79], v[88:91]
    ds_read_b64 a[8:9], v2 offset:1024
    v_mfma_f32_16x16x32_bf16 v[92:95], a[52:55], a[80:83], v[92:95]
    ds_read_b64 a[10:11], v2 offset:1032
    s_waitcnt lgkmcnt(10)
    v_mfma_f32_16x16x32_bf16 v[84:87], a[56:59], a[68:71], v[84:87]
    ds_read_b128 a[20:23], v5 offset:1536
    v_mfma_f32_16x16x32_bf16 v[88:91], a[56:59], a[72:75], v[88:91]
    ds_read_b64 a[12:13], v2 offset:512
    v_mfma_f32_16x16x32_bf16 v[92:95], a[56:59], a[76:79], v[92:95]
    ds_read_b64 a[14:15], v2 offset:520
    v_mfma_f32_16x16x32_bf16 v[84:87], a[60:63], a[64:67], v[84:87]
    ds_read_b128 a[16:19], v5 offset:1024
    v_mfma_f32_16x16x32_bf16 v[88:91], a[60:63], a[68:71], v[88:91]
    v_subrev_u32 v2, 64, v2
    v_mfma_f32_16x16x32_bf16 v[92:95], a[60:63], a[72:75], v[92:95]
    v_subrev_u32 v5, 64, v5
    s_sub_u32 s32, s32, 1
    s_cmp_lg_u32 s32, 0
    s_cbranch_scc1 L_a_convb
    v_cvt_pk_bf16_f32 v46, v84, v85
    v_cvt_pk_bf16_f32 v47, v86, v87
    ds_write_b64 v6, v[46:47] offset:2560
    v_cvt_pk_bf16_f32 v48, v88, v89
    v_cvt_pk_bf16_f32 v49, v90, v91
    ds_write_b64 v6, v[48:49] offset:3072
    v_cvt_pk_bf16_f32 v50, v92, v93
    v_cvt_pk_bf16_f32 v51, v94, v95
    ds_write_b64 v6, v[50:51] offset:3584
    s_waitcnt lgkmcnt(0)
    s_barrier
    s_cmp_ge_u32 s24, 6
    s_cbranch_scc1 L_a_done
    ds_read_b32 v24, v23 offset:3072
    ds_read_b32 v25, v23 offset:7680
    ds_read_b32 v26, v23 offset:12288
    ds_read_b32 v27, v23 offset:16896
    ds_read_b32 v28, v23 offset:21504
    ds_read_b32 v29, v23 offset:26112
    ds_read_b32 v30, v23 offset:30720
    ds_read_b32 v31, v23 offset:35328
    s_mov_b32 s35, 2949120
    v_add_u32 v12, s35, v14
    s_waitcnt lgkmcnt(0)
    v_perm_b32 v44, v25, v24, s30
    v_perm_b32 v45, v27, v26, s30
    v_perm_b32 v46, v29, v28, s30
    v_perm_b32 v47, v31, v30, s30
    global_store_dwordx4 v12, v[44:47], s[52:53] offset:0
    v_perm_b32 v48, v25, v24, s31
    v_perm_b32 v49, v27, v26, s31
    v_perm_b32 v50, v29, v28, s31
    v_perm_b32 v51, v31, v30, s31
    global_store_dwordx4 v12, v[48:51], s[52:53] offset:2304
L_a_done:
    s_endpgm
L_sec_cmain:
    s_barrier
    ds_read_b128 a[0:3], v4 offset:0
    ds_read_b128 a[4:7], v4 offset:2048
    ds_read_b64_tr_b16 v[80:81], v6 offset:0
    ds_read_b64_tr_b16 v[82:83], v6 offset:4608
    ds_read_b64_tr_b16 v[84:85], v6 offset:32
    ds_read_b64_tr_b16 v[86:87], v6 offset:4640
    ds_read_b64_tr_b16 v[88:89], v6 offset:64
    ds_read_b64_tr_b16 v[90:91], v6 offset:4672
    ds_read_b64_tr_b16 v[92:93], v6 offset:96
    ds_read_b64_tr_b16 v[94:95], v6 offset:4704
    s_waitcnt lgkmcnt(6)
    v_mfma_f32_16x16x32_bf16 v[8:11], a[0:3], v[80:83], v[108:111]
    ds_read_b64_tr_b16 v[96:97], v6 offset:128
    v_mfma_f32_16x16x32_bf16 v[12:15], a[4:7], v[80:83], v[108:111]
    ds_read_b64_tr_b16 v[98:99], v6 offset:4736
    s_waitcnt lgkmcnt(6)
    v_mfma_f32_16x16x32_bf16 v[16:19], a[0:3], v[84:87], v[108:111]
    ds_read_b64_tr_b16 v[100:101], v6 offset:160
    v_mfma_f32_16x16x32_bf16 v[20:23], a[4:7], v[84:87], v[108:111]
    ds_read_b64_tr_b16 v[102:103], v6 offset:4768
    s_waitcnt lgkmcnt(6)
    v_mfma_f32_16x16x32_bf16 v[24:27], a[0:3], v[88:91], v[108:111]
    ds_read_b64_tr_b16 v[80:81], v6 offset:192
    v_mfma_f32_16x16x32_bf16 v[28:31], a[4:7], v[88:91], v[108:111]
    ds_read_b64_tr_b16 v[82:83], v6 offset:4800
    s_waitcnt lgkmcnt(6)
    v_mfma_f32_16x16x32_bf16 v[32:35], a[0:3], v[92:95], v[108:111]
    ds_read_b64_tr_b16 v[84:85], v6 offset:224
    v_mfma_f32_16x16x32_bf16 v[36:39], a[4:7], v[92:95], v[108:111]
    ds_read_b64_tr_b16 v[86:87], v6 offset:4832
    s_waitcnt lgkmcnt(6)
    v_mfma_f32_16x16x32_bf16 v[40:43], a[0:3], v[96:99], v[104:107]
    ds_read_b64_tr_b16 v[88:89], v6 offset:256
    v_mfma_f32_16x16x32_bf16 v[44:47], a[4:7], v[96:99], v[104:107]
    ds_read_b64_tr_b16 v[90:91], v6 offset:4864
    s_waitcnt lgkmcnt(6)
    v_mfma_f32_16x16x32_bf16 v[48:51], a[0:3], v[100:103], 0
    ds_read_b128 a[8:11], v5 offset:0
    ds_read_b128 a[12:15], v5 offset:2048
    v_mfma_f32_16x16x32_bf16 v[52:55], a[4:7], v[100:103], 0
    ds_read_b64_tr_b16 v[92:93], v6 offset:9216
    ds_read_b64_tr_b16 v[94:95], v6 offset:13824
    s_waitcnt lgkmcnt(8)
    v_mfma_f32_16x16x32_bf16 v[56:59], a[0:3], v[80:83], 0
    ds_read_b64_tr_b16 v[96:97], v6 offset:9248
    v_mfma_f32_16x16x32_bf16 v[60:63], a[4:7], v[80:83], 0
    ds_read_b64_tr_b16 v[98:99], v6 offset:13856
    s_waitcnt lgkmcnt(8)
    v_mfma_f32_16x16x32_bf16 v[64:67], a[0:3], v[84:87], 0
    ds_read_b64_tr_b16 v[100:101], v6 offset:9280
    v_mfma_f32_16x16x32_bf16 v[68:71], a[4:7], v[84:87], 0
    ds_read_b64_tr_b16 v[102:103], v6 offset:13888
    s_waitcnt lgkmcnt(8)
    v_mfma_f32_16x16x32_bf16 v[72:75], a[0:3], v[88:91], 0
    ds_read_b64_tr_b16 v[80:81], v6 offset:9312
    v_mfma_f32_16x16x32_bf16 v[76:79], a[4:7], v[88:91], 0
    ds_read_b64_tr_b16 v[82:83], v6 offset:13920
    s_waitcnt lgkmcnt(6)
    v_mfma_f32_16x16x32_bf16 v[8:11], a[8:11], v[92:95], v[8:11]
    ds_read_b64_tr_b16 v[84:85], v6 offset:9344
    v_mfma_f32_16x16x32_bf16 v[12:15], a[12:15], v[92:95], v[12:15]
    ds_read_b64_tr_b16 v[86:87], v6 offset:13952
    s_waitcnt lgkmcnt(6)
    v_mfma_f32_16x16x32_bf16 v[16:19], a[8:11], v[96:99], v[16:19]
    ds_read_b64_tr_b16 v[88:89], v6 offset:9376
    v_mfma_f32_16x16x32_bf16 v[20:23], a[12:15], v[96:99], v[20:23]
    ds_read_b64_tr_b16 v[90:91], v6 offset:13984
    s_waitcnt lgkmcnt(6)
    v_mfma_f32_16x16x32_bf16 v[24:27], a[8:11], v[100:103], v[24:27]
    ds_read_b64_tr_b16 v[92:93], v6 offset:9408
    v_mfma_f32_16x16x32_bf16 v[28:31], a[12:15], v[100:103], v[28:31]
    ds_read_b64_tr_b16 v[94:95], v6 offset:14016
    s_waitcnt lgkmcnt(6)
    v_mfma_f32_16x16x32_bf16 v[32:35], a[8:11], v[80:83], v[32:35]
    ds_read_b64_tr_b16 v[96:97], v6 offset:9440
    v_mfma_f32_16x16x32_bf16 v[36:39], a[12:15], v[80:83], v[36:39]
    ds_read_b64_tr_b16 v[98:99], v6 offset:14048
    s_waitcnt lgkmcnt(6)
    v_mfma_f32_16x16x32_bf16 v[40:43], a[8:11], v[84:87], v[40:43]
    ds_read_b64_tr_b16 v[100:101], v6 offset:9472
    v_mfma_f32_16x16x32_bf16 v[44:47], a[12:15], v[84:87], v[44:47]
    ds_read_b64_tr_b16 v[102:103], v6 offset:14080
    s_add_u32 s16, s14, 393216
    s_addc_u32 s17, s15, 0
    s_mov_b32 s18, 2359296
    s_mov_b32 s19, 0x20000
    s_lshl_b32 s32, s25, 3
    s_lshl_b32 s33, s24, 1
    s_add_u32 s32, s32, s33
    s_mul_i32 s32, s32, 18432
    v_lshl_add_u32 v105, v1, 4, s32
    v_add_u32 v106, 18432, v105
    s_lshl_b32 s20, s26, 11
    s_lshr_b32 s33, s26, 2
    s_lshl_b32 s33, s33, 10
    s_and_b32 s34, s26, 3
    s_lshl_b32 s34, s34, 8
    s_add_u32 s33, s33, s34
    s_add_u32 s33, s33, s32
    s_add_u32 s33, s33, 16368
    s_movk_i32 s21, 18432
    s_add_u32 s45, s20, 2048
    s_and_b32 s45, s45, 0x3fff
    s_add_u32 s46, s20, 4096
    s_and_b32 s46, s46, 0x3fff
    s_add_u32 s47, s20, 6144
    s_and_b32 s47, s47, 0x3fff
    s_add_u32 s48, s20, 8192
    s_and_b32 s48, s48, 0x3fff
    s_add_u32 s49, s20, 10240
    s_and_b32 s49, s49, 0x3fff
    s_add_u32 s50, s20, 12288
    s_and_b32 s50, s50, 0x3fff
    s_add_u32 s51, s20, 14336
    s_and_b32 s51, s51, 0x3fff
    v_lshlrev_b32 v104, 4, v2
    v_lshl_add_u32 v104, v3, 3, v104
    v_add_u32 v104, s33, v104
    s_waitcnt lgkmcnt(6)
    v_mfma_f32_16x16x32_bf16 v[48:51], a[8:11], v[88:91], v[48:51]
    v_add_u32 v4, 34816, v4
    v_add_u32 v5, 34816, v5
    v_add_u32 v6, 34816, v6
    s_barrier
    ds_read_b128 a[16:19], v4 offset:0
    ds_read_b128 a[20:23], v4 offset:2048
    v_mfma_f32_16x16x32_bf16 v[52:55], a[12:15], v[88:91], v[52:55]
    ds_read_b64_tr_b16 v[80:81], v6 offset:0
    ds_read_b64_tr_b16 v[82:83], v6 offset:4608
    s_waitcnt lgkmcnt(8)
    v_mfma_f32_16x16x32_bf16 v[56:59], a[8:11], v[92:95], v[56:59]
    ds_read_b64_tr_b16 v[84:85], v6 offset:32
    v_mfma_f32_16x16x32_bf16 v[60:63], a[12:15], v[92:95], v[60:63]
    ds_read_b64_tr_b16 v[86:87], v6 offset:4640
    s_waitcnt lgkmcnt(8)
    v_mfma_f32_16x16x32_bf16 v[64:67], a[8:11], v[96:99], v[64:67]
    ds_read_b64_tr_b16 v[88:89], v6 offset:64
    v_mfma_f32_16x16x32_bf16 v[68:71], a[12:15], v[96:99], v[68:71]
    ds_read_b64_tr_b16 v[90:91], v6 offset:4672
    s_waitcnt lgkmcnt(8)
    v_mfma_f32_16x16x32_bf16 v[72:75], a[8:11], v[100:103], v[72:75]
    ds_read_b64_tr_b16 v[92:93], v6 offset:96
    v_mfma_f32_16x16x32_bf16 v[76:79], a[12:15], v[100:103], v[76:79]
    ds_read_b64_tr_b16 v[94:95], v6 offset:4704
    s_waitcnt lgkmcnt(6)
    v_mfma_f32_16x16x32_bf16 v[8:11], a[16:19], v[80:83], v[8:11]
    ds_read_b64_tr_b16 v[96:97], v6 offset:128
    v_mfma_f32_16x16x32_bf16 v[12:15], a[20:23], v[80:83], v[12:15]
    ds_read_b64_tr_b16 v[98:99], v6 offset:4736
    s_waitcnt lgkmcnt(6)
    v_mfma_f32_16x16x32_bf16 v[16:19], a[16:19], v[84:87], v[16:19]
    ds_read_b64_tr_b16 v[100:101], v6 offset:160
    v_mfma_f32_16x16x32_bf16 v[20:23], a[20:23], v[84:87], v[20:23]
    ds_read_b64_tr_b16 v[102:103], v6 offset:4768
    s_waitcnt lgkmcnt(6)
    v_mfma_f32_16x16x32_bf16 v[24:27], a[16:19], v[88:91], v[24:27]
    ds_read_b64_tr_b16 v[80:81], v6 offset:192
    v_mfma_f32_16x16x32_bf16 v[28:31], a[20:23], v[88:91], v[28:31]
    ds_read_b64_tr_b16 v[82:83], v6 offset:4800
    s_waitcnt lgkmcnt(6)
    v_mfma_f32_16x16x32_bf16 v[32:35], a[16:19], v[92:95], v[32:35]
    ds_read_b64_tr_b16 v[84:85], v6 offset:224
    v_mfma_f32_16x16x32_bf16 v[36:39], a[20:23], v[92:95], v[36:39]
    ds_read_b64_tr_b16 v[86:87], v6 offset:4832
    s_waitcnt lgkmcnt(6)
    v_mfma_f32_16x16x32_bf16 v[40:43], a[16:19], v[96:99], v[40:43]
    ds_read_b64_tr_b16 v[88:89], v6 offset:256
    v_mfma_f32_16x16x32_bf16 v[44:47], a[20:23], v[96:99], v[44:47]
    ds_read_b64_tr_b16 v[90:91], v6 offset:4864
    s_waitcnt lgkmcnt(6)
    v_mfma_f32_16x16x32_bf16 v[48:51], a[16:19], v[100:103], v[48:51]
    ds_read_b128 a[24:27], v5 offset:0
    ds_read_b128 a[28:31], v5 offset:2048
    v_mfma_f32_16x16x32_bf16 v[52:55], a[20:23], v[100:103], v[52:55]
    ds_read_b64_tr_b16 v[92:93], v6 offset:9216
    ds_read_b64_tr_b16 v[94:95], v6 offset:13824
    s_waitcnt lgkmcnt(8)
    v_mfma_f32_16x16x32_bf16 v[56:59], a[16:19], v[80:83], v[56:59]
    ds_read_b64_tr_b16 v[96:97], v6 offset:9248
    v_mfma_f32_16x16x32_bf16 v[60:63], a[20:23], v[80:83], v[60:63]
    ds_read_b64_tr_b16 v[98:99], v6 offset:13856
    s_waitcnt lgkmcnt(8)
    v_mfma_f32_16x16x32_bf16 v[64:67], a[16:19], v[84:87], v[64:67]
    ds_read_b64_tr_b16 v[100:101], v6 offset:9280
    v_mfma_f32_16x16x32_bf16 v[68:71], a[20:23], v[84:87], v[68:71]
    ds_read_b64_tr_b16 v[102:103], v6 offset:13888
    s_waitcnt lgkmcnt(8)
    v_mfma_f32_16x16x32_bf16 v[72:75], a[16:19], v[88:91], v[72:75]
    ds_read_b64_tr_b16 v[80:81], v6 offset:9312
    v_mfma_f32_16x16x32_bf16 v[76:79], a[20:23], v[88:91], v[76:79]
    ds_read_b64_tr_b16 v[82:83], v6 offset:13920
    s_waitcnt lgkmcnt(6)
    v_mfma_f32_16x16x32_bf16 v[8:11], a[24:27], v[92:95], v[8:11]
    ds_read_b64_tr_b16 v[84:85], v6 offset:9344
    v_mfma_f32_16x16x32_bf16 v[12:15], a[28:31], v[92:95], v[12:15]
    ds_read_b64_tr_b16 v[86:87], v6 offset:13952
    s_waitcnt lgkmcnt(6)
    v_mfma_f32_16x16x32_bf16 v[16:19], a[24:27], v[96:99], v[16:19]
    ds_read_b64_tr_b16 v[88:89], v6 offset:9376
    v_mfma_f32_16x16x32_bf16 v[20:23], a[28:31], v[96:99], v[20:23]
    ds_read_b64_tr_b16 v[90:91], v6 offset:13984
    s_waitcnt lgkmcnt(6)
    v_mfma_f32_16x16x32_bf16 v[24:27], a[24:27], v[100:103], v[24:27]
    ds_read_b64_tr_b16 v[92:93], v6 offset:9408
    v_mfma_f32_16x16x32_bf16 v[28:31], a[28:31], v[100:103], v[28:31]
    ds_read_b64_tr_b16 v[94:95], v6 offset:14016
    s_waitcnt lgkmcnt(6)
    v_mfma_f32_16x16x32_bf16 v[32:35], a[24:27], v[80:83], v[32:35]
    ds_read_b64_tr_b16 v[96:97], v6 offset:9440
    v_mfma_f32_16x16x32_bf16 v[36:39], a[28:31], v[80:83], v[36:39]
    ds_read_b64_tr_b16 v[98:99], v6 offset:14048
    s_waitcnt lgkmcnt(6)
    v_mfma_f32_16x16x32_bf16 v[40:43], a[24:27], v[84:87], v[40:43]
    ds_read_b64_tr_b16 v[100:101], v6 offset:9472
    v_mfma_f32_16x16x32_bf16 v[44:47], a[28:31], v[84:87], v[44:47]
    ds_read_b64_tr_b16 v[102:103], v6 offset:14080
    s_waitcnt lgkmcnt(6)
    v_mfma_f32_16x16x32_bf16 v[48:51], a[24:27], v[88:91], v[48:51]
    v_add_u32 v4, 34816, v4
    v_add_u32 v5, 34816, v5
    v_add_u32 v6, 34816, v6
    s_barrier
    ds_read_b128 a[32:35], v4 offset:0
    ds_read_b128 a[36:39], v4 offset:2048
    v_mfma_f32_16x16x32_bf16 v[52:55], a[28:31], v[88:91], v[52:55]
    ds_read_b64_tr_b16 v[80:81], v6 offset:0
    ds_read_b64_tr_b16 v[82:83], v6 offset:4608
    s_waitcnt lgkmcnt(8)
    v_mfma_f32_16x16x32_bf16 v[56:59], a[24:27], v[92:95], v[56:59]
    ds_read_b64_tr_b16 v[84:85], v6 offset:32
    v_mfma_f32_16x16x32_bf16 v[60:63], a[28:31], v[92:95], v[60:63]
    ds_read_b64_tr_b16 v[86:87], v6 offset:4640
    s_waitcnt lgkmcnt(8)
    v_mfma_f32_16x16x32_bf16 v[64:67], a[24:27], v[96:99], v[64:67]
    ds_read_b64_tr_b16 v[88:89], v6 offset:64
    v_mfma_f32_16x16x32_bf16 v[68:71], a[28:31], v[96:99], v[68:71]
    ds_read_b64_tr_b16 v[90:91], v6 offset:4672
    s_waitcnt lgkmcnt(8)
    v_mfma_f32_16x16x32_bf16 v[72:75], a[24:27], v[100:103], v[72:75]
    ds_read_b64_tr_b16 v[92:93], v6 offset:96
    v_mfma_f32_16x16x32_bf16 v[76:79], a[28:31], v[100:103], v[76:79]
    ds_read_b64_tr_b16 v[94:95], v6 offset:4704
    s_waitcnt lgkmcnt(6)
    v_mfma_f32_16x16x32_bf16 v[8:11], a[32:35], v[80:83], v[8:11]
    ds_read_b64_tr_b16 v[96:97], v6 offset:128
    v_mfma_f32_16x16x32_bf16 v[12:15], a[36:39], v[80:83], v[12:15]
    ds_read_b64_tr_b16 v[98:99], v6 offset:4736
    s_waitcnt lgkmcnt(6)
    v_mfma_f32_16x16x32_bf16 v[16:19], a[32:35], v[84:87], v[16:19]
    ds_read_b64_tr_b16 v[100:101], v6 offset:160
    v_mfma_f32_16x16x32_bf16 v[20:23], a[36:39], v[84:87], v[20:23]
    ds_read_b64_tr_b16 v[102:103], v6 offset:4768
    s_waitcnt lgkmcnt(6)
    v_mfma_f32_16x16x32_bf16 v[24:27], a[32:35], v[88:91], v[24:27]
    ds_read_b64_tr_b16 v[80:81], v6 offset:192
    v_mfma_f32_16x16x32_bf16 v[28:31], a[36:39], v[88:91], v[28:31]
    ds_read_b64_tr_b16 v[82:83], v6 offset:4800
    s_waitcnt lgkmcnt(6)
    v_mfma_f32_16x16x32_bf16 v[32:35], a[32:35], v[92:95], v[32:35]
    ds_read_b64_tr_b16 v[84:85], v6 offset:224
    v_mfma_f32_16x16x32_bf16 v[36:39], a[36:39], v[92:95], v[36:39]
    ds_read_b64_tr_b16 v[86:87], v6 offset:4832
    s_waitcnt lgkmcnt(6)
    v_mfma_f32_16x16x32_bf16 v[40:43], a[32:35], v[96:99], v[40:43]
    ds_read_b64_tr_b16 v[88:89], v6 offset:256
    v_mfma_f32_16x16x32_bf16 v[44:47], a[36:39], v[96:99], v[44:47]
    ds_read_b64_tr_b16 v[90:91], v6 offset:4864
    s_waitcnt lgkmcnt(6)
    v_mfma_f32_16x16x32_bf16 v[48:51], a[32:35], v[100:103], v[48:51]
    ds_read_b128 a[40:43], v5 offset:0
    ds_read_b128 a[44:47], v5 offset:2048
    v_mfma_f32_16x16x32_bf16 v[52:55], a[36:39], v[100:103], v[52:55]
    ds_read_b64_tr_b16 v[92:93], v6 offset:9216
    ds_read_b64_tr_b16 v[94:95], v6 offset:13824
    s_waitcnt lgkmcnt(8)
    v_mfma_f32_16x16x32_bf16 v[56:59], a[32:35], v[80:83], v[56:59]
    ds_read_b64_tr_b16 v[96:97], v6 offset:9248
    v_mfma_f32_16x16x32_bf16 v[60:63], a[36:39], v[80:83], v[60:63]
    ds_read_b64_tr_b16 v[98:99], v6 offset:13856
    s_waitcnt lgkmcnt(8)
    v_mfma_f32_16x16x32_bf16 v[64:67], a[32:35], v[84:87], v[64:67]
    ds_read_b64_tr_b16 v[100:101], v6 offset:9280
    v_mfma_f32_16x16x32_bf16 v[68:71], a[36:39], v[84:87], v[68:71]
    ds_read_b64_tr_b16 v[102:103], v6 offset:13888
    s_waitcnt lgkmcnt(8)
    v_mfma_f32_16x16x32_bf16 v[72:75], a[32:35], v[88:91], v[72:75]
    ds_read_b64_tr_b16 v[80:81], v6 offset:9312
    v_mfma_f32_16x16x32_bf16 v[76:79], a[36:39], v[88:91], v[76:79]
    ds_read_b64_tr_b16 v[82:83], v6 offset:13920
    s_waitcnt lgkmcnt(6)
    v_mfma_f32_16x16x32_bf16 v[8:11], a[40:43], v[92:95], v[8:11]
    ds_read_b64_tr_b16 v[84:85], v6 offset:9344
    v_mfma_f32_16x16x32_bf16 v[12:15], a[44:47], v[92:95], v[12:15]
    ds_read_b64_tr_b16 v[86:87], v6 offset:13952
    s_waitcnt lgkmcnt(6)
    v_mfma_f32_16x16x32_bf16 v[16:19], a[40:43], v[96:99], v[16:19]
    ds_read_b64_tr_b16 v[88:89], v6 offset:9376
    v_mfma_f32_16x16x32_bf16 v[20:23], a[44:47], v[96:99], v[20:23]
    ds_read_b64_tr_b16 v[90:91], v6 offset:13984
    s_waitcnt lgkmcnt(6)
    v_mfma_f32_16x16x32_bf16 v[24:27], a[40:43], v[100:103], v[24:27]
    ds_read_b64_tr_b16 v[92:93], v6 offset:9408
    v_mfma_f32_16x16x32_bf16 v[28:31], a[44:47], v[100:103], v[28:31]
    ds_read_b64_tr_b16 v[94:95], v6 offset:14016
    s_waitcnt lgkmcnt(6)
    v_mfma_f32_16x16x32_bf16 v[32:35], a[40:43], v[80:83], v[32:35]
    ds_read_b64_tr_b16 v[96:97], v6 offset:9440
    v_mfma_f32_16x16x32_bf16 v[36:39], a[44:47], v[80:83], v[36:39]
    ds_read_b64_tr_b16 v[98:99], v6 offset:14048
    s_waitcnt lgkmcnt(6)
    v_mfma_f32_16x16x32_bf16 v[40:43], a[40:43], v[84:87], v[40:43]
    ds_read_b64_tr_b16 v[100:101], v6 offset:9472
    v_mfma_f32_16x16x32_bf16 v[44:47], a[44:47], v[84:87], v[44:47]
    ds_read_b64_tr_b16 v[102:103], v6 offset:14080
    s_waitcnt lgkmcnt(6)
    v_mfma_f32_16x16x32_bf16 v[48:51], a[40:43], v[88:91], v[48:51]
    v_add_u32 v4, 34816, v4
    v_add_u32 v5, 34816, v5
    v_add_u32 v6, 34816, v6
    s_barrier
    ds_read_b128 a[48:51], v4 offset:0
    ds_read_b128 a[52:55], v4 offset:2048
    v_mfma_f32_16x16x32_bf16 v[52:55], a[44:47], v[88:91], v[52:55]
    ds_read_b64_tr_b16 v[80:81], v6 offset:0
    ds_read_b64_tr_b16 v[82:83], v6 offset:4608
    s_waitcnt lgkmcnt(8)
    v_mfma_f32_16x16x32_bf16 v[56:59], a[40:43], v[92:95], v[56:59]
    ds_read_b64_tr_b16 v[84:85], v6 offset:32
    v_mfma_f32_16x16x32_bf16 v[60:63], a[44:47], v[92:95], v[60:63]
    ds_read_b64_tr_b16 v[86:87], v6 offset:4640
    s_waitcnt lgkmcnt(8)
    v_mfma_f32_16x16x32_bf16 v[64:67], a[40:43], v[96:99], v[64:67]
    ds_read_b64_tr_b16 v[88:89], v6 offset:64
    v_mfma_f32_16x16x32_bf16 v[68:71], a[44:47], v[96:99], v[68:71]
    ds_read_b64_tr_b16 v[90:91], v6 offset:4672
    s_waitcnt lgkmcnt(8)
    v_mfma_f32_16x16x32_bf16 v[72:75], a[40:43], v[100:103], v[72:75]
    ds_read_b64_tr_b16 v[92:93], v6 offset:96
    v_mfma_f32_16x16x32_bf16 v[76:79], a[44:47], v[100:103], v[76:79]
    ds_read_b64_tr_b16 v[94:95], v6 offset:4704
    s_waitcnt lgkmcnt(6)
    v_mfma_f32_16x16x32_bf16 v[8:11], a[48:51], v[80:83], v[8:11]
    ds_read_b64_tr_b16 v[96:97], v6 offset:128
    v_mfma_f32_16x16x32_bf16 v[12:15], a[52:55], v[80:83], v[12:15]
    ds_read_b64_tr_b16 v[98:99], v6 offset:4736
    s_waitcnt lgkmcnt(6)
    v_mfma_f32_16x16x32_bf16 v[16:19], a[48:51], v[84:87], v[16:19]
    ds_read_b64_tr_b16 v[100:101], v6 offset:160
    v_mfma_f32_16x16x32_bf16 v[20:23], a[52:55], v[84:87], v[20:23]
    ds_read_b64_tr_b16 v[102:103], v6 offset:4768
    s_waitcnt lgkmcnt(6)
    v_mfma_f32_16x16x32_bf16 v[24:27], a[48:51], v[88:91], v[24:27]
    ds_read_b64_tr_b16 v[80:81], v6 offset:192
    v_mfma_f32_16x16x32_bf16 v[28:31], a[52:55], v[88:91], v[28:31]
    ds_read_b64_tr_b16 v[82:83], v6 offset:4800
    s_waitcnt lgkmcnt(6)
    v_mfma_f32_16x16x32_bf16 v[32:35], a[48:51], v[92:95], v[32:35]
    ds_read_b64_tr_b16 v[84:85], v6 offset:224
    v_mfma_f32_16x16x32_bf16 v[36:39], a[52:55], v[92:95], v[36:39]
    ds_read_b64_tr_b16 v[86:87], v6 offset:4832
    s_waitcnt lgkmcnt(6)
    v_mfma_f32_16x16x32_bf16 v[40:43], a[48:51], v[96:99], v[40:43]
    ds_read_b64_tr_b16 v[88:89], v6 offset:256
    v_mfma_f32_16x16x32_bf16 v[44:47], a[52:55], v[96:99], v[44:47]
    ds_read_b64_tr_b16 v[90:91], v6 offset:4864
    s_waitcnt lgkmcnt(6)
    v_mfma_f32_16x16x32_bf16 v[48:51], a[48:51], v[100:103], v[48:51]
    ds_read_b128 a[56:59], v5 offset:0
    ds_read_b128 a[60:63], v5 offset:2048
    v_mfma_f32_16x16x32_bf16 v[52:55], a[52:55], v[100:103], v[52:55]
    ds_read_b64_tr_b16 v[92:93], v6 offset:9216
    ds_read_b64_tr_b16 v[94:95], v6 offset:13824
    s_waitcnt lgkmcnt(8)
    v_mfma_f32_16x16x32_bf16 v[56:59], a[48:51], v[80:83], v[56:59]
    ds_read_b64_tr_b16 v[96:97], v6 offset:9248
    v_mfma_f32_16x16x32_bf16 v[60:63], a[52:55], v[80:83], v[60:63]
    ds_read_b64_tr_b16 v[98:99], v6 offset:13856
    s_waitcnt lgkmcnt(8)
    v_mfma_f32_16x16x32_bf16 v[64:67], a[48:51], v[84:87], v[64:67]
    ds_read_b64_tr_b16 v[100:101], v6 offset:9280
    v_mfma_f32_16x16x32_bf16 v[68:71], a[52:55], v[84:87], v[68:71]
    ds_read_b64_tr_b16 v[102:103], v6 offset:13888
    s_waitcnt lgkmcnt(8)
    v_mfma_f32_16x16x32_bf16 v[72:75], a[48:51], v[88:91], v[72:75]
    ds_read_b64_tr_b16 v[80:81], v6 offset:9312
    v_mfma_f32_16x16x32_bf16 v[76:79], a[52:55], v[88:91], v[76:79]
    ds_read_b64_tr_b16 v[82:83], v6 offset:13920
    s_waitcnt lgkmcnt(6)
    v_mfma_f32_16x16x32_bf16 v[8:11], a[56:59], v[92:95], v[8:11]
    ds_read_b64_tr_b16 v[84:85], v6 offset:9344
    v_mfma_f32_16x16x32_bf16 v[12:15], a[60:63], v[92:95], v[12:15]
    ds_read_b64_tr_b16 v[86:87], v6 offset:13952
    s_waitcnt lgkmcnt(6)
    v_mfma_f32_16x16x32_bf16 v[16:19], a[56:59], v[96:99], v[16:19]
    ds_read_b64_tr_b16 v[88:89], v6 offset:9376
    v_mfma_f32_16x16x32_bf16 v[20:23], a[60:63], v[96:99], v[20:23]
    ds_read_b64_tr_b16 v[90:91], v6 offset:13984
    s_waitcnt lgkmcnt(6)
    v_mfma_f32_16x16x32_bf16 v[24:27], a[56:59], v[100:103], v[24:27]
    ds_read_b64_tr_b16 v[92:93], v6 offset:9408
    v_mfma_f32_16x16x32_bf16 v[28:31], a[60:63], v[100:103], v[28:31]
    ds_read_b64_tr_b16 v[94:95], v6 offset:14016
    s_waitcnt lgkmcnt(6)
    v_mfma_f32_16x16x32_bf16 v[32:35], a[56:59], v[80:83], v[32:35]
    ds_read_b64_tr_b16 v[96:97], v6 offset:9440
    v_mfma_f32_16x16x32_bf16 v[36:39], a[60:63], v[80:83], v[36:39]
    ds_read_b64_tr_b16 v[98:99], v6 offset:14048
    s_waitcnt lgkmcnt(6)
    v_mfma_f32_16x16x32_bf16 v[40:43], a[56:59], v[84:87], v[40:43]
    ds_read_b64_tr_b16 v[100:101], v6 offset:9472
    v_mfma_f32_16x16x32_bf16 v[44:47], a[60:63], v[84:87], v[44:47]
    ds_read_b64_tr_b16 v[102:103], v6 offset:14080
    s_waitcnt lgkmcnt(6)
    v_mfma_f32_16x16x32_bf16 v[48:51], a[56:59], v[88:91], v[48:51]
    v_subrev_u32 v4, 104448, v4
    v_subrev_u32 v5, 104448, v5
    v_subrev_u32 v6, 104448, v6
    s_barrier
    ds_read_b128 a[64:67], v4 offset:0
    ds_read_b128 a[68:71], v4 offset:2048
    v_mfma_f32_16x16x32_bf16 v[52:55], a[60:63], v[88:91], v[52:55]
    ds_read_b64_tr_b16 v[80:81], v6 offset:0
    ds_read_b64_tr_b16 v[82:83], v6 offset:4608
    s_waitcnt lgkmcnt(8)
    v_mfma_f32_16x16x32_bf16 v[56:59], a[56:59], v[92:95], v[56:59]
    ds_read_b64_tr_b16 v[84:85], v6 offset:32
    v_mfma_f32_16x16x32_bf16 v[60:63], a[60:63], v[92:95], v[60:63]
    ds_read_b64_tr_b16 v[86:87], v6 offset:4640
    s_waitcnt lgkmcnt(8)
    v_mfma_f32_16x16x32_bf16 v[64:67], a[56:59], v[96:99], v[64:67]
    ds_read_b64_tr_b16 v[88:89], v6 offset:64
    v_mfma_f32_16x16x32_bf16 v[68:71], a[60:63], v[96:99], v[68:71]
    ds_read_b64_tr_b16 v[90:91], v6 offset:4672
    s_waitcnt lgkmcnt(8)
    v_mfma_f32_16x16x32_bf16 v[72:75], a[56:59], v[100:103], v[72:75]
    ds_read_b64_tr_b16 v[92:93], v6 offset:96
    v_mfma_f32_16x16x32_bf16 v[76:79], a[60:63], v[100:103], v[76:79]
    ds_read_b64_tr_b16 v[94:95], v6 offset:4704
    s_waitcnt lgkmcnt(6)
    v_mfma_f32_16x16x32_bf16 v[8:11], a[64:67], v[80:83], v[8:11]
    ds_read_b64_tr_b16 v[96:97], v6 offset:128
    v_mfma_f32_16x16x32_bf16 v[12:15], a[68:71], v[80:83], v[12:15]
    ds_read_b64_tr_b16 v[98:99], v6 offset:4736
    s_waitcnt lgkmcnt(6)
    v_mfma_f32_16x16x32_bf16 v[16:19], a[64:67], v[84:87], v[16:19]
    ds_read_b64_tr_b16 v[100:101], v6 offset:160
    v_mfma_f32_16x16x32_bf16 v[20:23], a[68:71], v[84:87], v[20:23]
    ds_read_b64_tr_b16 v[102:103], v6 offset:4768
    s_waitcnt lgkmcnt(6)
    v_mfma_f32_16x16x32_bf16 v[24:27], a[64:67], v[88:91], v[24:27]
    ds_read_b64_tr_b16 v[80:81], v6 offset:192
    v_mfma_f32_16x16x32_bf16 v[28:31], a[68:71], v[88:91], v[28:31]
    ds_read_b64_tr_b16 v[82:83], v6 offset:4800
    s_waitcnt lgkmcnt(6)
    v_mfma_f32_16x16x32_bf16 v[32:35], a[64:67], v[92:95], v[32:35]
    ds_read_b64_tr_b16 v[84:85], v6 offset:224
    v_mfma_f32_16x16x32_bf16 v[36:39], a[68:71], v[92:95], v[36:39]
    ds_read_b64_tr_b16 v[86:87], v6 offset:4832
    s_waitcnt lgkmcnt(6)
    v_mfma_f32_16x16x32_bf16 v[40:43], a[64:67], v[96:99], v[40:43]
    ds_read_b64_tr_b16 v[88:89], v6 offset:256
    v_mfma_f32_16x16x32_bf16 v[44:47], a[68:71], v[96:99], v[44:47]
    ds_read_b64_tr_b16 v[90:91], v6 offset:4864
    s_waitcnt lgkmcnt(6)
    v_mfma_f32_16x16x32_bf16 v[48:51], a[64:67], v[100:103], v[48:51]
    ds_read_b128 a[72:75], v5 offset:0
    ds_read_b128 a[76:79], v5 offset:2048
    v_mfma_f32_16x16x32_bf16 v[52:55], a[68:71], v[100:103], v[52:55]
    ds_read_b64_tr_b16 v[92:93], v6 offset:9216
    ds_read_b64_tr_b16 v[94:95], v6 offset:13824
    s_waitcnt lgkmcnt(8)
    v_mfma_f32_16x16x32_bf16 v[56:59], a[64:67], v[80:83], v[56:59]
    ds_read_b64_tr_b16 v[96:97], v6 offset:9248
    v_mfma_f32_16x16x32_bf16 v[60:63], a[68:71], v[80:83], v[60:63]
    ds_read_b64_tr_b16 v[98:99], v6 offset:13856
    s_waitcnt lgkmcnt(8)
    v_mfma_f32_16x16x32_bf16 v[64:67], a[64:67], v[84:87], v[64:67]
    ds_read_b64_tr_b16 v[100:101], v6 offset:9280
    v_mfma_f32_16x16x32_bf16 v[68:71], a[68:71], v[84:87], v[68:71]
    ds_read_b64_tr_b16 v[102:103], v6 offset:13888
    s_waitcnt lgkmcnt(8)
    v_mfma_f32_16x16x32_bf16 v[72:75], a[64:67], v[88:91], v[72:75]
    ds_read_b64_tr_b16 v[80:81], v6 offset:9312
    v_mfma_f32_16x16x32_bf16 v[76:79], a[68:71], v[88:91], v[76:79]
    ds_read_b64_tr_b16 v[82:83], v6 offset:13920
    s_waitcnt lgkmcnt(6)
    v_mfma_f32_16x16x32_bf16 v[8:11], a[72:75], v[92:95], v[8:11]
    ds_read_b64_tr_b16 v[84:85], v6 offset:9344
    v_mfma_f32_16x16x32_bf16 v[12:15], a[76:79], v[92:95], v[12:15]
    ds_read_b64_tr_b16 v[86:87], v6 offset:13952
    s_waitcnt lgkmcnt(6)
    v_mfma_f32_16x16x32_bf16 v[16:19], a[72:75], v[96:99], v[16:19]
    ds_read_b64_tr_b16 v[88:89], v6 offset:9376
    v_mfma_f32_16x16x32_bf16 v[20:23], a[76:79], v[96:99], v[20:23]
    ds_read_b64_tr_b16 v[90:91], v6 offset:13984
    s_waitcnt lgkmcnt(6)
    v_mfma_f32_16x16x32_bf16 v[24:27], a[72:75], v[100:103], v[24:27]
    ds_read_b64_tr_b16 v[92:93], v6 offset:9408
    v_mfma_f32_16x16x32_bf16 v[28:31], a[76:79], v[100:103], v[28:31]
    ds_read_b64_tr_b16 v[94:95], v6 offset:14016
    s_waitcnt lgkmcnt(6)
    v_mfma_f32_16x16x32_bf16 v[32:35], a[72:75], v[80:83], v[32:35]
    ds_read_b64_tr_b16 v[96:97], v6 offset:9440
    v_mfma_f32_16x16x32_bf16 v[36:39], a[76:79], v[80:83], v[36:39]
    ds_read_b64_tr_b16 v[98:99], v6 offset:14048
    s_waitcnt lgkmcnt(6)
    v_mfma_f32_16x16x32_bf16 v[40:43], a[72:75], v[84:87], v[40:43]
    ds_read_b64_tr_b16 v[100:101], v6 offset:9472
    v_mfma_f32_16x16x32_bf16 v[44:47], a[76:79], v[84:87], v[44:47]
    ds_read_b64_tr_b16 v[102:103], v6 offset:14080
    s_waitcnt lgkmcnt(6)
    v_mfma_f32_16x16x32_bf16 v[48:51], a[72:75], v[88:91], v[48:51]
    v_add_u32 v4, 34816, v4
    v_add_u32 v5, 34816, v5
    v_add_u32 v6, 34816, v6
    s_barrier
    ds_read_b128 a[80:83], v4 offset:0
    ds_read_b128 a[84:87], v4 offset:2048
    v_mfma_f32_16x16x32_bf16 v[52:55], a[76:79], v[88:91], v[52:55]
    ds_read_b64_tr_b16 v[80:81], v6 offset:0
    ds_read_b64_tr_b16 v[82:83], v6 offset:4608
    s_waitcnt lgkmcnt(8)
    v_mfma_f32_16x16x32_bf16 v[56:59], a[72:75], v[92:95], v[56:59]
    ds_read_b64_tr_b16 v[84:85], v6 offset:32
    v_mfma_f32_16x16x32_bf16 v[60:63], a[76:79], v[92:95], v[60:63]
    ds_read_b64_tr_b16 v[86:87], v6 offset:4640
    s_waitcnt lgkmcnt(8)
    v_mfma_f32_16x16x32_bf16 v[64:67], a[72:75], v[96:99], v[64:67]
    ds_read_b64_tr_b16 v[88:89], v6 offset:64
    v_mfma_f32_16x16x32_bf16 v[68:71], a[76:79], v[96:99], v[68:71]
    ds_read_b64_tr_b16 v[90:91], v6 offset:4672
    s_waitcnt lgkmcnt(8)
    v_mfma_f32_16x16x32_bf16 v[72:75], a[72:75], v[100:103], v[72:75]
    ds_read_b64_tr_b16 v[92:93], v6 offset:96
    v_mfma_f32_16x16x32_bf16 v[76:79], a[76:79], v[100:103], v[76:79]
    ds_read_b64_tr_b16 v[94:95], v6 offset:4704
    s_waitcnt lgkmcnt(6)
    v_mfma_f32_16x16x32_bf16 v[8:11], a[80:83], v[80:83], v[8:11]
    ds_read_b64_tr_b16 v[96:97], v6 offset:128
    v_mfma_f32_16x16x32_bf16 v[12:15], a[84:87], v[80:83], v[12:15]
    ds_read_b64_tr_b16 v[98:99], v6 offset:4736
    s_waitcnt lgkmcnt(6)
    v_mfma_f32_16x16x32_bf16 v[16:19], a[80:83], v[84:87], v[16:19]
    ds_read_b64_tr_b16 v[100:101], v6 offset:160
    v_mfma_f32_16x16x32_bf16 v[20:23], a[84:87], v[84:87], v[20:23]
    ds_read_b64_tr_b16 v[102:103], v6 offset:4768
    s_waitcnt lgkmcnt(6)
    v_mfma_f32_16x16x32_bf16 v[24:27], a[80:83], v[88:91], v[24:27]
    ds_read_b64_tr_b16 v[80:81], v6 offset:192
    v_mfma_f32_16x16x32_bf16 v[28:31], a[84:87], v[88:91], v[28:31]
    ds_read_b64_tr_b16 v[82:83], v6 offset:4800
    s_waitcnt lgkmcnt(6)
    v_mfma_f32_16x16x32_bf16 v[32:35], a[80:83], v[92:95], v[32:35]
    ds_read_b64_tr_b16 v[84:85], v6 offset:224
    v_mfma_f32_16x16x32_bf16 v[36:39], a[84:87], v[92:95], v[36:39]
    ds_read_b64_tr_b16 v[86:87], v6 offset:4832
    s_waitcnt lgkmcnt(6)
    v_mfma_f32_16x16x32_bf16 v[40:43], a[80:83], v[96:99], v[40:43]
    ds_read_b64_tr_b16 v[88:89], v6 offset:256
    v_mfma_f32_16x16x32_bf16 v[44:47], a[84:87], v[96:99], v[44:47]
    ds_read_b64_tr_b16 v[90:91], v6 offset:4864
    s_waitcnt lgkmcnt(6)
    v_mfma_f32_16x16x32_bf16 v[48:51], a[80:83], v[100:103], v[48:51]
    ds_read_b128 a[88:91], v5 offset:0
    ds_read_b128 a[92:95], v5 offset:2048
    v_mfma_f32_16x16x32_bf16 v[52:55], a[84:87], v[100:103], v[52:55]
    ds_read_b64_tr_b16 v[92:93], v6 offset:9216
    ds_read_b64_tr_b16 v[94:95], v6 offset:13824
    s_waitcnt lgkmcnt(8)
    v_mfma_f32_16x16x32_bf16 v[56:59], a[80:83], v[80:83], v[56:59]
    ds_read_b64_tr_b16 v[96:97], v6 offset:9248
    v_mfma_f32_16x16x32_bf16 v[60:63], a[84:87], v[80:83], v[60:63]
    ds_read_b64_tr_b16 v[98:99], v6 offset:13856
    s_waitcnt lgkmcnt(8)
    v_mfma_f32_16x16x32_bf16 v[64:67], a[80:83], v[84:87], v[64:67]
    ds_read_b64_tr_b16 v[100:101], v6 offset:9280
    v_mfma_f32_16x16x32_bf16 v[68:71], a[84:87], v[84:87], v[68:71]
    ds_read_b64_tr_b16 v[102:103], v6 offset:13888
    s_waitcnt lgkmcnt(8)
    v_mfma_f32_16x16x32_bf16 v[72:75], a[80:83], v[88:91], v[72:75]
    ds_read_b64_tr_b16 v[80:81], v6 offset:9312
    v_mfma_f32_16x16x32_bf16 v[76:79], a[84:87], v[88:91], v[76:79]
    ds_read_b64_tr_b16 v[82:83], v6 offset:13920
    s_waitcnt lgkmcnt(6)
    v_mfma_f32_16x16x32_bf16 v[8:11], a[88:91], v[92:95], v[8:11]
    ds_read_b64_tr_b16 v[84:85], v6 offset:9344
    v_mfma_f32_16x16x32_bf16 v[12:15], a[92:95], v[92:95], v[12:15]
    ds_read_b64_tr_b16 v[86:87], v6 offset:13952
    s_waitcnt lgkmcnt(6)
    v_mfma_f32_16x16x32_bf16 v[16:19], a[88:91], v[96:99], v[16:19]
    ds_read_b64_tr_b16 v[88:89], v6 offset:9376
    v_mfma_f32_16x16x32_bf16 v[20:23], a[92:95], v[96:99], v[20:23]
    ds_read_b64_tr_b16 v[90:91], v6 offset:13984
    s_waitcnt lgkmcnt(6)
    v_mfma_f32_16x16x32_bf16 v[24:27], a[88:91], v[100:103], v[24:27]
    ds_read_b64_tr_b16 v[92:93], v6 offset:9408
    v_mfma_f32_16x16x32_bf16 v[28:31], a[92:95], v[100:103], v[28:31]
    ds_read_b64_tr_b16 v[94:95], v6 offset:14016
    s_waitcnt lgkmcnt(6)
    v_mfma_f32_16x16x32_bf16 v[32:35], a[88:91], v[80:83], v[32:35]
    ds_read_b64_tr_b16 v[96:97], v6 offset:9440
    v_mfma_f32_16x16x32_bf16 v[36:39], a[92:95], v[80:83], v[36:39]
    ds_read_b64_tr_b16 v[98:99], v6 offset:14048
    s_waitcnt lgkmcnt(6)
    v_mfma_f32_16x16x32_bf16 v[40:43], a[88:91], v[84:87], v[40:43]
    ds_read_b64_tr_b16 v[100:101], v6 offset:9472
    v_mfma_f32_16x16x32_bf16 v[44:47], a[92:95], v[84:87], v[44:47]
    ds_read_b64_tr_b16 v[102:103], v6 offset:14080
    s_waitcnt lgkmcnt(6)
    v_mfma_f32_16x16x32_bf16 v[48:51], a[88:91], v[88:91], v[48:51]
    v_add_u32 v4, 34816, v4
    v_add_u32 v5, 34816, v5
    v_add_u32 v6, 34816, v6
    s_barrier
    ds_read_b128 a[96:99], v4 offset:0
    ds_read_b128 a[100:103], v4 offset:2048
    v_mfma_f32_16x16x32_bf16 v[52:55], a[92:95], v[88:91], v[52:55]
    ds_read_b64_tr_b16 v[80:81], v6 offset:0
    ds_read_b64_tr_b16 v[82:83], v6 offset:4608
    s_waitcnt lgkmcnt(8)
    v_mfma_f32_16x16x32_bf16 v[56:59], a[88:91], v[92:95], v[56:59]
    ds_read_b64_tr_b16 v[84:85], v6 offset:32
    v_mfma_f32_16x16x32_bf16 v[60:63], a[92:95], v[92:95], v[60:63]
    ds_read_b64_tr_b16 v[86:87], v6 offset:4640
    s_waitcnt lgkmcnt(8)
    v_mfma_f32_16x16x32_bf16 v[64:67], a[88:91], v[96:99], v[64:67]
    ds_read_b64_tr_b16 v[88:89], v6 offset:64
    v_mfma_f32_16x16x32_bf16 v[68:71], a[92:95], v[96:99], v[68:71]
    ds_read_b64_tr_b16 v[90:91], v6 offset:4672
    s_waitcnt lgkmcnt(8)
    v_mfma_f32_16x16x32_bf16 v[72:75], a[88:91], v[100:103], v[72:75]
    ds_read_b64_tr_b16 v[92:93], v6 offset:96
    v_mfma_f32_16x16x32_bf16 v[76:79], a[92:95], v[100:103], v[76:79]
    ds_read_b64_tr_b16 v[94:95], v6 offset:4704
    s_waitcnt lgkmcnt(6)
    v_mfma_f32_16x16x32_bf16 v[8:11], a[96:99], v[80:83], v[8:11]
    ds_read_b64_tr_b16 v[96:97], v6 offset:128
    v_mfma_f32_16x16x32_bf16 v[12:15], a[100:103], v[80:83], v[12:15]
    ds_read_b64_tr_b16 v[98:99], v6 offset:4736
    s_waitcnt lgkmcnt(6)
    v_mfma_f32_16x16x32_bf16 v[16:19], a[96:99], v[84:87], v[16:19]
    ds_read_b64_tr_b16 v[100:101], v6 offset:160
    v_mfma_f32_16x16x32_bf16 v[20:23], a[100:103], v[84:87], v[20:23]
    ds_read_b64_tr_b16 v[102:103], v6 offset:4768
    s_waitcnt lgkmcnt(6)
    v_mfma_f32_16x16x32_bf16 v[24:27], a[96:99], v[88:91], v[24:27]
    ds_read_b64_tr_b16 v[80:81], v6 offset:192
    v_mfma_f32_16x16x32_bf16 v[28:31], a[100:103], v[88:91], v[28:31]
    ds_read_b64_tr_b16 v[82:83], v6 offset:4800
    s_waitcnt lgkmcnt(6)
    v_mfma_f32_16x16x32_bf16 v[32:35], a[96:99], v[92:95], v[32:35]
    ds_read_b64_tr_b16 v[84:85], v6 offset:224
    v_mfma_f32_16x16x32_bf16 v[36:39], a[100:103], v[92:95], v[36:39]
    ds_read_b64_tr_b16 v[86:87], v6 offset:4832
    s_waitcnt lgkmcnt(6)
    v_mfma_f32_16x16x32_bf16 v[40:43], a[96:99], v[96:99], v[40:43]
    ds_read_b64_tr_b16 v[88:89], v6 offset:256
    v_mfma_f32_16x16x32_bf16 v[44:47], a[100:103], v[96:99], v[44:47]
    ds_read_b64_tr_b16 v[90:91], v6 offset:4864
    s_waitcnt lgkmcnt(6)
    v_mfma_f32_16x16x32_bf16 v[48:51], a[96:99], v[100:103], v[48:51]
    ds_read_b128 a[104:107], v5 offset:0
    ds_read_b128 a[108:111], v5 offset:2048
    v_mfma_f32_16x16x32_bf16 v[52:55], a[100:103], v[100:103], v[52:55]
    ds_read_b64_tr_b16 v[92:93], v6 offset:9216
    ds_read_b64_tr_b16 v[94:95], v6 offset:13824
    s_waitcnt lgkmcnt(8)
    v_mfma_f32_16x16x32_bf16 v[56:59], a[96:99], v[80:83], v[56:59]
    ds_read_b64_tr_b16 v[96:97], v6 offset:9248
    v_mfma_f32_16x16x32_bf16 v[60:63], a[100:103], v[80:83], v[60:63]
    ds_read_b64_tr_b16 v[98:99], v6 offset:13856
    s_waitcnt lgkmcnt(8)
    v_mfma_f32_16x16x32_bf16 v[64:67], a[96:99], v[84:87], v[64:67]
    ds_read_b64_tr_b16 v[100:101], v6 offset:9280
    v_mfma_f32_16x16x32_bf16 v[68:71], a[100:103], v[84:87], v[68:71]
    ds_read_b64_tr_b16 v[102:103], v6 offset:13888
    s_waitcnt lgkmcnt(8)
    v_mfma_f32_16x16x32_bf16 v[72:75], a[96:99], v[88:91], v[72:75]
    ds_read_b64_tr_b16 v[80:81], v6 offset:9312
    v_mfma_f32_16x16x32_bf16 v[76:79], a[100:103], v[88:91], v[76:79]
    ds_read_b64_tr_b16 v[82:83], v6 offset:13920
    s_waitcnt lgkmcnt(6)
    v_mfma_f32_16x16x32_bf16 v[8:11], a[104:107], v[92:95], v[8:11]
    ds_read_b64_tr_b16 v[84:85], v6 offset:9344
    v_mfma_f32_16x16x32_bf16 v[12:15], a[108:111], v[92:95], v[12:15]
    ds_read_b64_tr_b16 v[86:87], v6 offset:13952
    s_waitcnt lgkmcnt(6)
    v_mfma_f32_16x16x32_bf16 v[16:19], a[104:107], v[96:99], v[16:19]
    ds_read_b64_tr_b16 v[88:89], v6 offset:9376
    v_mfma_f32_16x16x32_bf16 v[20:23], a[108:111], v[96:99], v[20:23]
    ds_read_b64_tr_b16 v[90:91], v6 offset:13984
    s_waitcnt lgkmcnt(6)
    v_mfma_f32_16x16x32_bf16 v[24:27], a[104:107], v[100:103], v[24:27]
    ds_read_b64_tr_b16 v[92:93], v6 offset:9408
    v_mfma_f32_16x16x32_bf16 v[28:31], a[108:111], v[100:103], v[28:31]
    ds_read_b64_tr_b16 v[94:95], v6 offset:14016
    s_waitcnt lgkmcnt(6)
    v_mfma_f32_16x16x32_bf16 v[32:35], a[104:107], v[80:83], v[32:35]
    ds_read_b64_tr_b16 v[96:97], v6 offset:9440
    v_mfma_f32_16x16x32_bf16 v[36:39], a[108:111], v[80:83], v[36:39]
    ds_read_b64_tr_b16 v[98:99], v6 offset:14048
    s_waitcnt lgkmcnt(6)
    v_mfma_f32_16x16x32_bf16 v[40:43], a[104:107], v[84:87], v[40:43]
    ds_read_b64_tr_b16 v[100:101], v6 offset:9472
    v_mfma_f32_16x16x32_bf16 v[44:47], a[108:111], v[84:87], v[44:47]
    ds_read_b64_tr_b16 v[102:103], v6 offset:14080
    s_waitcnt lgkmcnt(6)
    v_mfma_f32_16x16x32_bf16 v[48:51], a[104:107], v[88:91], v[48:51]
    v_add_u32 v4, 34816, v4
    v_add_u32 v5, 34816, v5
    v_add_u32 v6, 34816, v6
    s_barrier
    ds_read_b128 a[112:115], v4 offset:0
    ds_read_b128 a[116:119], v4 offset:2048
    v_mfma_f32_16x16x32_bf16 v[52:55], a[108:111], v[88:91], v[52:55]
    ds_read_b64_tr_b16 v[80:81], v6 offset:0
    ds_read_b64_tr_b16 v[82:83], v6 offset:4608
    s_waitcnt lgkmcnt(8)
    v_mfma_f32_16x16x32_bf16 v[56:59], a[104:107], v[92:95], v[56:59]
    ds_read_b64_tr_b16 v[84:85], v6 offset:32
    v_mfma_f32_16x16x32_bf16 v[60:63], a[108:111], v[92:95], v[60:63]
    ds_read_b64_tr_b16 v[86:87], v6 offset:4640
    s_waitcnt lgkmcnt(8)
    v_mfma_f32_16x16x32_bf16 v[64:67], a[104:107], v[96:99], v[64:67]
    ds_read_b64_tr_b16 v[88:89], v6 offset:64
    v_mfma_f32_16x16x32_bf16 v[68:71], a[108:111], v[96:99], v[68:71]
    ds_read_b64_tr_b16 v[90:91], v6 offset:4672
    s_waitcnt lgkmcnt(8)
    v_mfma_f32_16x16x32_bf16 v[72:75], a[104:107], v[100:103], v[72:75]
    ds_read_b64_tr_b16 v[92:93], v6 offset:96
    v_mfma_f32_16x16x32_bf16 v[76:79], a[108:111], v[100:103], v[76:79]
    ds_read_b64_tr_b16 v[94:95], v6 offset:4704
    s_waitcnt lgkmcnt(6)
    v_mfma_f32_16x16x32_bf16 v[8:11], a[112:115], v[80:83], v[8:11]
    ds_read_b64_tr_b16 v[96:97], v6 offset:128
    v_mfma_f32_16x16x32_bf16 v[12:15], a[116:119], v[80:83], v[12:15]
    ds_read_b64_tr_b16 v[98:99], v6 offset:4736
    s_waitcnt lgkmcnt(6)
    v_mfma_f32_16x16x32_bf16 v[16:19], a[112:115], v[84:87], v[16:19]
    ds_read_b64_tr_b16 v[100:101], v6 offset:160
    v_mfma_f32_16x16x32_bf16 v[20:23], a[116:119], v[84:87], v[20:23]
    ds_read_b64_tr_b16 v[102:103], v6 offset:4768
    s_waitcnt lgkmcnt(6)
    v_mfma_f32_16x16x32_bf16 v[24:27], a[112:115], v[88:91], v[24:27]
    ds_read_b64_tr_b16 v[80:81], v6 offset:192
    v_mfma_f32_16x16x32_bf16 v[28:31], a[116:119], v[88:91], v[28:31]
    ds_read_b64_tr_b16 v[82:83], v6 offset:4800
    s_waitcnt lgkmcnt(6)
    v_mfma_f32_16x16x32_bf16 v[32:35], a[112:115], v[92:95], v[32:35]
    ds_read_b64_tr_b16 v[84:85], v6 offset:224
    v_mfma_f32_16x16x32_bf16 v[36:39], a[116:119], v[92:95], v[36:39]
    ds_read_b64_tr_b16 v[86:87], v6 offset:4832
    s_waitcnt lgkmcnt(6)
    v_mfma_f32_16x16x32_bf16 v[40:43], a[112:115], v[96:99], v[40:43]
    ds_read_b64_tr_b16 v[88:89], v6 offset:256
    v_mfma_f32_16x16x32_bf16 v[44:47], a[116:119], v[96:99], v[44:47]
    ds_read_b64_tr_b16 v[90:91], v6 offset:4864
    s_waitcnt lgkmcnt(6)
    v_mfma_f32_16x16x32_bf16 v[48:51], a[112:115], v[100:103], v[48:51]
    ds_read_b128 a[120:123], v5 offset:0
    ds_read_b128 a[124:127], v5 offset:2048
    v_mfma_f32_16x16x32_bf16 v[52:55], a[116:119], v[100:103], v[52:55]
    ds_read_b64_tr_b16 v[92:93], v6 offset:9216
    ds_read_b64_tr_b16 v[94:95], v6 offset:13824
    s_waitcnt lgkmcnt(8)
    v_mfma_f32_16x16x32_bf16 v[56:59], a[112:115], v[80:83], v[56:59]
    ds_read_b64_tr_b16 v[96:97], v6 offset:9248
    v_mfma_f32_16x16x32_bf16 v[60:63], a[116:119], v[80:83], v[60:63]
    ds_read_b64_tr_b16 v[98:99], v6 offset:13856
    s_waitcnt lgkmcnt(8)
    v_mfma_f32_16x16x32_bf16 v[64:67], a[112:115], v[84:87], v[64:67]
    ds_read_b64_tr_b16 v[100:101], v6 offset:9280
    v_mfma_f32_16x16x32_bf16 v[68:71], a[116:119], v[84:87], v[68:71]
    ds_read_b64_tr_b16 v[102:103], v6 offset:13888
    s_waitcnt lgkmcnt(8)
    v_mfma_f32_16x16x32_bf16 v[72:75], a[112:115], v[88:91], v[72:75]
    ds_read_b64_tr_b16 v[80:81], v6 offset:9312
    v_mfma_f32_16x16x32_bf16 v[76:79], a[116:119], v[88:91], v[76:79]
    ds_read_b64_tr_b16 v[82:83], v6 offset:13920
    s_waitcnt lgkmcnt(6)
    v_mfma_f32_16x16x32_bf16 v[8:11], a[120:123], v[92:95], v[8:11]
    ds_read_b64_tr_b16 v[84:85], v6 offset:9344
    v_mfma_f32_16x16x32_bf16 v[12:15], a[124:127], v[92:95], v[12:15]
    ds_read_b64_tr_b16 v[86:87], v6 offset:13952
    s_waitcnt lgkmcnt(6)
    v_mfma_f32_16x16x32_bf16 v[16:19], a[120:123], v[96:99], v[16:19]
    ds_read_b64_tr_b16 v[88:89], v6 offset:9376
    v_mfma_f32_16x16x32_bf16 v[20:23], a[124:127], v[96:99], v[20:23]
    ds_read_b64_tr_b16 v[90:91], v6 offset:13984
    s_waitcnt lgkmcnt(6)
    v_mfma_f32_16x16x32_bf16 v[24:27], a[120:123], v[100:103], v[24:27]
    ds_read_b64_tr_b16 v[92:93], v6 offset:9408
    v_mfma_f32_16x16x32_bf16 v[28:31], a[124:127], v[100:103], v[28:31]
    ds_read_b64_tr_b16 v[94:95], v6 offset:14016
    s_waitcnt lgkmcnt(6)
    v_mfma_f32_16x16x32_bf16 v[32:35], a[120:123], v[80:83], v[32:35]
    ds_read_b64_tr_b16 v[96:97], v6 offset:9440
    v_mfma_f32_16x16x32_bf16 v[36:39], a[124:127], v[80:83], v[36:39]
    ds_read_b64_tr_b16 v[98:99], v6 offset:14048
    s_waitcnt lgkmcnt(6)
    v_mfma_f32_16x16x32_bf16 v[40:43], a[120:123], v[84:87], v[40:43]
    ds_read_b64_tr_b16 v[100:101], v6 offset:9472
    v_mfma_f32_16x16x32_bf16 v[44:47], a[124:127], v[84:87], v[44:47]
    ds_read_b64_tr_b16 v[102:103], v6 offset:14080
    s_waitcnt lgkmcnt(6)
    v_mfma_f32_16x16x32_bf16 v[48:51], a[120:123], v[88:91], v[48:51]
    v_subrev_u32 v4, 104448, v4
    v_subrev_u32 v5, 104448, v5
    v_subrev_u32 v6, 104448, v6
    s_waitcnt lgkmcnt(0)
    s_barrier
    ds_read_b128 a[128:131], v4 offset:0
    ds_read_b128 a[132:135], v4 offset:2048
    v_mfma_f32_16x16x32_bf16 v[52:55], a[124:127], v[88:91], v[52:55]
    ds_read_b64_tr_b16 v[80:81], v6 offset:0
    ds_read_b64_tr_b16 v[82:83], v6 offset:4608
    s_waitcnt lgkmcnt(8)
    v_mfma_f32_16x16x32_bf16 v[56:59], a[120:123], v[92:95], v[56:59]
    ds_read_b64_tr_b16 v[84:85], v6 offset:32
    v_mfma_f32_16x16x32_bf16 v[60:63], a[124:127], v[92:95], v[60:63]
    ds_read_b64_tr_b16 v[86:87], v6 offset:4640
    s_waitcnt lgkmcnt(8)
    v_mfma_f32_16x16x32_bf16 v[64:67], a[120:123], v[96:99], v[64:67]
    ds_read_b64_tr_b16 v[88:89], v6 offset:64
    v_mfma_f32_16x16x32_bf16 v[68:71], a[124:127], v[96:99], v[68:71]
    ds_read_b64_tr_b16 v[90:91], v6 offset:4672
    s_waitcnt lgkmcnt(8)
    v_mfma_f32_16x16x32_bf16 v[72:75], a[120:123], v[100:103], v[72:75]
    ds_read_b64_tr_b16 v[92:93], v6 offset:96
    v_mfma_f32_16x16x32_bf16 v[76:79], a[124:127], v[100:103], v[76:79]
    ds_read_b64_tr_b16 v[94:95], v6 offset:4704
    s_waitcnt lgkmcnt(6)
    v_mfma_f32_16x16x32_bf16 v[8:11], a[128:131], v[80:83], v[8:11]
    ds_read_b64_tr_b16 v[96:97], v6 offset:128
    v_mfma_f32_16x16x32_bf16 v[12:15], a[132:135], v[80:83], v[12:15]
    ds_read_b64_tr_b16 v[98:99], v6 offset:4736
    s_waitcnt lgkmcnt(6)
    v_mfma_f32_16x16x32_bf16 v[16:19], a[128:131], v[84:87], v[16:19]
    ds_read_b128 a[136:139], v5 offset:0
    ds_read_b128 a[140:143], v5 offset:2048
    v_mfma_f32_16x16x32_bf16 v[20:23], a[132:135], v[84:87], v[20:23]
    ds_read_b64_tr_b16 v[100:101], v6 offset:9216
    ds_read_b64_tr_b16 v[102:103], v6 offset:13824
    s_waitcnt lgkmcnt(8)
    v_mfma_f32_16x16x32_bf16 v[24:27], a[128:131], v[88:91], v[24:27]
    ds_read_b64_tr_b16 v[80:81], v6 offset:9248
    v_mfma_f32_16x16x32_bf16 v[28:31], a[132:135], v[88:91], v[28:31]
    ds_read_b64_tr_b16 v[82:83], v6 offset:13856
    s_waitcnt lgkmcnt(8)
    v_mfma_f32_16x16x32_bf16 v[32:35], a[128:131], v[92:95], v[32:35]
    ds_read_b64_tr_b16 v[84:85], v6 offset:9280
    v_mfma_f32_16x16x32_bf16 v[36:39], a[132:135], v[92:95], v[36:39]
    ds_read_b64_tr_b16 v[86:87], v6 offset:13888
    s_waitcnt lgkmcnt(8)
    v_mfma_f32_16x16x32_bf16 v[40:43], a[128:131], v[96:99], v[40:43]
    ds_read_b64_tr_b16 v[88:89], v6 offset:9312
    v_mfma_f32_16x16x32_bf16 v[44:47], a[132:135], v[96:99], v[44:47]
    ds_read_b64_tr_b16 v[90:91], v6 offset:13920
    s_waitcnt lgkmcnt(6)
    v_mfma_f32_16x16x32_bf16 v[8:11], a[136:139], v[100:103], v[8:11]
    ds_read_b64_tr_b16 v[92:93], v6 offset:9344
    v_mfma_f32_16x16x32_bf16 v[12:15], a[140:143], v[100:103], v[12:15]
    ds_read_b64_tr_b16 v[94:95], v6 offset:13952
    s_waitcnt lgkmcnt(6)
    v_mfma_f32_16x16x32_bf16 v[16:19], a[136:139], v[80:83], v[16:19]
    ds_read_b64_tr_b16 v[96:97], v6 offset:160
    v_mfma_f32_16x16x32_bf16 v[20:23], a[140:143], v[80:83], v[20:23]
    ds_read_b64_tr_b16 v[98:99], v6 offset:4768
    s_waitcnt lgkmcnt(6)
    v_mfma_f32_16x16x32_bf16 v[24:27], a[136:139], v[84:87], v[24:27]
    ds_read_b64_tr_b16 v[100:101], v6 offset:192
    v_mfma_f32_16x16x32_bf16 v[28:31], a[140:143], v[84:87], v[28:31]
    ds_read_b64_tr_b16 v[102:103], v6 offset:4800
    s_waitcnt lgkmcnt(6)
    v_mfma_f32_16x16x32_bf16 v[32:35], a[136:139], v[88:91], v[32:35]
    ds_read_b64_tr_b16 v[80:81], v6 offset:224
    v_mfma_f32_16x16x32_bf16 v[36:39], a[140:143], v[88:91], v[36:39]
    ds_read_b64_tr_b16 v[82:83], v6 offset:4832
    s_waitcnt lgkmcnt(6)
    v_mfma_f32_16x16x32_bf16 v[40:43], a[136:139], v[92:95], v[40:43]
    ds_read_b64_tr_b16 v[84:85], v6 offset:256
    v_mfma_f32_16x16x32_bf16 v[44:47], a[140:143], v[92:95], v[44:47]
    ds_read_b64_tr_b16 v[86:87], v6 offset:4864
    s_waitcnt lgkmcnt(6)
    v_mfma_f32_16x16x32_bf16 v[48:51], a[128:131], v[96:99], v[48:51]
    ds_read_b64_tr_b16 v[88:89], v6 offset:9376
    v_mfma_f32_16x16x32_bf16 v[52:55], a[132:135], v[96:99], v[52:55]
    ds_read_b64_tr_b16 v[90:91], v6 offset:13984
    s_waitcnt lgkmcnt(6)
    v_mfma_f32_16x16x32_bf16 v[56:59], a[128:131], v[100:103], v[56:59]
    ds_read_b64_tr_b16 v[92:93], v6 offset:9408
    v_mfma_f32_16x16x32_bf16 v[60:63], a[132:135], v[100:103], v[60:63]
    ds_read_b64_tr_b16 v[94:95], v6 offset:14016
    s_waitcnt lgkmcnt(6)
    v_mfma_f32_16x16x32_bf16 v[64:67], a[128:131], v[80:83], v[64:67]
    ds_read_b64_tr_b16 v[96:97], v6 offset:9440
    v_mfma_f32_16x16x32_bf16 v[68:71], a[132:135], v[80:83], v[68:71]
    ds_read_b64_tr_b16 v[98:99], v6 offset:14048
    s_waitcnt lgkmcnt(6)
    v_mfma_f32_16x16x32_bf16 v[72:75], a[128:131], v[84:87], v[72:75]
    ds_read_b64_tr_b16 v[100:101], v6 offset:9472
    v_mfma_f32_16x16x32_bf16 v[76:79], a[132:135], v[84:87], v[76:79]
    ds_read_b64_tr_b16 v[102:103], v6 offset:14080
    s_waitcnt lgkmcnt(6)
    v_mfma_f32_16x16x32_bf16 v[48:51], a[136:139], v[88:91], v[48:51]
    v_mfma_f32_16x16x32_bf16 v[52:55], a[140:143], v[88:91], v[52:55]
    s_waitcnt lgkmcnt(4)
    v_mfma_f32_16x16x32_bf16 v[56:59], a[136:139], v[92:95], v[56:59]
    v_mfma_f32_16x16x32_bf16 v[60:63], a[140:143], v[92:95], v[60:63]
    s_waitcnt lgkmcnt(2)
    v_mfma_f32_16x16x32_bf16 v[64:67], a[136:139], v[96:99], v[64:67]
    v_mfma_f32_16x16x32_bf16 v[68:71], a[140:143], v[96:99], v[68:71]
    s_waitcnt lgkmcnt(0)
    v_mfma_f32_16x16x32_bf16 v[72:75], a[136:139], v[100:103], v[72:75]
    v_mfma_f32_16x16x32_bf16 v[76:79], a[140:143], v[100:103], v[76:79]
    s_lshl_b32 s32, s24, 13
    s_add_u32 s32, s32, 104448
    v_lshl_add_u32 v4, v1, 4, s32
    s_lshl_b32 s32, s24, 12
    v_lshl_add_u32 v5, v1, 4, s32
    v_pk_mul_f32 v[80:81], v[8:9], s[36:37]
    v_pk_mul_f32 v[84:85], v[10:11], s[36:37]
    v_pk_mul_f32 v[88:89], v[12:13], s[36:37]
    v_pk_mul_f32 v[92:93], v[14:15], s[36:37]
    v_max_f32 v82, s38, v8
    v_max_f32 v86, s38, v10
    v_max_f32 v90, s38, v12
    v_max_f32 v94, s38, v14
    v_exp_f32_e64 v80, v80 clamp
    v_exp_f32_e64 v84, v84 clamp
    v_exp_f32_e64 v88, v88 clamp
    v_exp_f32_e64 v92, v92 clamp
    v_exp_f32_e64 v81, v81 clamp
    v_exp_f32_e64 v85, v85 clamp
    v_exp_f32_e64 v89, v89 clamp
    v_exp_f32_e64 v93, v93 clamp
    v_max_f32 v83, s38, v9
    v_max_f32 v87, s38, v11
    v_max_f32 v91, s38, v13
    v_max_f32 v95, s38, v15
    v_pk_add_f32 v[80:81], v[80:81], v[82:83]
    v_pk_add_f32 v[84:85], v[84:85], v[86:87]
    v_pk_add_f32 v[88:89], v[88:89], v[90:91]
    v_pk_add_f32 v[92:93], v[92:93], v[94:95]
    v_cvt_pk_bf16_f32 v8, v80, v81
    v_cvt_pk_bf16_f32 v9, v84, v85
    v_cvt_pk_bf16_f32 v10, v88, v89
    v_cvt_pk_bf16_f32 v11, v92, v93
    ds_write_b128 v4, v[8:11] offset:0
    v_cvt_pk_bf16_f32 v100, v40, v41
    v_cvt_pk_bf16_f32 v101, v42, v43
    v_cvt_pk_bf16_f32 v102, v44, v45
    v_cvt_pk_bf16_f32 v103, v46, v47
    ds_write_b128 v4, v[100:103] offset:5120
    v_pk_mul_f32 v[80:81], v[16:17], s[36:37]
    v_pk_mul_f32 v[84:85], v[18:19], s[36:37]
    v_pk_mul_f32 v[88:89], v[20:21], s[36:37]
    v_pk_mul_f32 v[92:93], v[22:23], s[36:37]
    v_max_f32 v82, s38, v16
    v_max_f32 v86, s38, v18
    v_max_f32 v90, s38, v20
    v_max_f32 v94, s38, v22
    v_exp_f32_e64 v80, v80 clamp
    v_exp_f32_e64 v84, v84 clamp
    v_exp_f32_e64 v88, v88 clamp
    v_exp_f32_e64 v92, v92 clamp
    v_exp_f32_e64 v81, v81 clamp
    v_exp_f32_e64 v85, v85 clamp
    v_exp_f32_e64 v89, v89 clamp
    v_exp_f32_e64 v93, v93 clamp
    v_max_f32 v83, s38, v17
    v_max_f32 v87, s38, v19
    v_max_f32 v91, s38, v21
    v_max_f32 v95, s38, v23
    v_pk_add_f32 v[80:81], v[80:81], v[82:83]
    v_pk_add_f32 v[84:85], v[84:85], v[86:87]
    v_pk_add_f32 v[88:89], v[88:89], v[90:91]
    v_pk_add_f32 v[92:93], v[92:93], v[94:95]
    v_cvt_pk_bf16_f32 v16, v80, v81
    v_cvt_pk_bf16_f32 v17, v84, v85
    v_cvt_pk_bf16_f32 v18, v88, v89
    v_cvt_pk_bf16_f32 v19, v92, v93
    ds_write_b128 v4, v[16:19] offset:1024
    v_cvt_pk_bf16_f32 v48, v48, v49
    v_cvt_pk_bf16_f32 v49, v50, v51
    v_cvt_pk_bf16_f32 v50, v52, v53
    v_cvt_pk_bf16_f32 v51, v54, v55
    ds_write_b128 v4, v[48:51] offset:6144
    v_pk_mul_f32 v[80:81], v[24:25], s[36:37]
    v_pk_mul_f32 v[84:85], v[26:27], s[36:37]
    v_pk_mul_f32 v[88:89], v[28:29], s[36:37]
    v_pk_mul_f32 v[92:93], v[30:31], s[36:37]
    v_max_f32 v82, s38, v24
    v_max_f32 v86, s38, v26
    v_max_f32 v90, s38, v28
    v_max_f32 v94, s38, v30
    v_exp_f32_e64 v80, v80 clamp
    v_exp_f32_e64 v84, v84 clamp
    v_exp_f32_e64 v88, v88 clamp
    v_exp_f32_e64 v92, v92 clamp
    v_exp_f32_e64 v81, v81 clamp
    v_exp_f32_e64 v85, v85 clamp
    v_exp_f32_e64 v89, v89 clamp
    v_exp_f32_e64 v93, v93 clamp
    v_max_f32 v83, s38, v25
    v_max_f32 v87, s38, v27
    v_max_f32 v91, s38, v29
    v_max_f32 v95, s38, v31
    v_pk_add_f32 v[80:81], v[80:81], v[82:83]
    v_pk_add_f32 v[84:85], v[84:85], v[86:87]
    v_pk_add_f32 v[88:89], v[88:89], v[90:91]
    v_pk_add_f32 v[92:93], v[92:93], v[94:95]
    v_cvt_pk_bf16_f32 v24, v80, v81
    v_cvt_pk_bf16_f32 v25, v84, v85
    v_cvt_pk_bf16_f32 v26, v88, v89
    v_cvt_pk_bf16_f32 v27, v92, v93
    ds_write_b128 v4, v[24:27] offset:2048
    v_cvt_pk_bf16_f32 v56, v56, v57
    v_cvt_pk_bf16_f32 v57, v58, v59
    v_cvt_pk_bf16_f32 v58, v60, v61
    v_cvt_pk_bf16_f32 v59, v62, v63
    ds_write_b128 v4, v[56:59] offset:7168
    v_pk_mul_f32 v[80:81], v[32:33], s[36:37]
    v_pk_mul_f32 v[84:85], v[34:35], s[36:37]
    v_pk_mul_f32 v[88:89], v[36:37], s[36:37]
    v_pk_mul_f32 v[92:93], v[38:39], s[36:37]
    v_max_f32 v82, s38, v32
    v_max_f32 v86, s38, v34
    v_max_f32 v90, s38, v36
    v_max_f32 v94, s38, v38
    v_exp_f32_e64 v80, v80 clamp
    v_exp_f32_e64 v84, v84 clamp
    v_exp_f32_e64 v88, v88 clamp
    v_exp_f32_e64 v92, v92 clamp
    v_exp_f32_e64 v81, v81 clamp
    v_exp_f32_e64 v85, v85 clamp
    v_exp_f32_e64 v89, v89 clamp
    v_exp_f32_e64 v93, v93 clamp
    v_max_f32 v83, s38, v33
    v_max_f32 v87, s38, v35
    v_max_f32 v91, s38, v37
    v_max_f32 v95, s38, v39
    v_pk_add_f32 v[80:81], v[80:81], v[82:83]
    v_pk_add_f32 v[84:85], v[84:85], v[86:87]
    v_pk_add_f32 v[88:89], v[88:89], v[90:91]
    v_pk_add_f32 v[92:93], v[92:93], v[94:95]
    v_cvt_pk_bf16_f32 v32, v80, v81
    v_cvt_pk_bf16_f32 v33, v84, v85
    v_cvt_pk_bf16_f32 v34, v88, v89
    v_cvt_pk_bf16_f32 v35, v92, v93
    ds_write_b128 v4, v[32:35] offset:3072
    v_cvt_pk_bf16_f32 v64, v64, v65
    v_cvt_pk_bf16_f32 v65, v66, v67
    v_cvt_pk_bf16_f32 v66, v68, v69
    v_cvt_pk_bf16_f32 v67, v70, v71
    ds_write_b128 v5, v[64:67] offset:0
    v_pk_mul_f32 v[80:81], v[40:41], s[36:37]
    v_pk_mul_f32 v[84:85], v[42:43], s[36:37]
    v_pk_mul_f32 v[88:89], v[44:45], s[36:37]
    v_pk_mul_f32 v[92:93], v[46:47], s[36:37]
    v_max_f32 v82, s38, v40
    v_max_f32 v86, s38, v42
    v_max_f32 v90, s38, v44
    v_max_f32 v94, s38, v46
    v_exp_f32_e64 v80, v80 clamp
    v_exp_f32_e64 v84, v84 clamp
    v_exp_f32_e64 v88, v88 clamp
    v_exp_f32_e64 v92, v92 clamp
    v_exp_f32_e64 v81, v81 clamp
    v_exp_f32_e64 v85, v85 clamp
    v_exp_f32_e64 v89, v89 clamp
    v_exp_f32_e64 v93, v93 clamp
    v_max_f32 v83, s38, v41
    v_max_f32 v87, s38, v43
    v_max_f32 v91, s38, v45
    v_max_f32 v95, s38, v47
    v_pk_add_f32 v[80:81], v[80:81], v[82:83]
    v_pk_add_f32 v[84:85], v[84:85], v[86:87]
    v_pk_add_f32 v[88:89], v[88:89], v[90:91]
    v_pk_add_f32 v[92:93], v[92:93], v[94:95]
    v_cvt_pk_bf16_f32 v96, v80, v81
    v_cvt_pk_bf16_f32 v97, v84, v85
    v_cvt_pk_bf16_f32 v98, v88, v89
    v_cvt_pk_bf16_f32 v99, v92, v93
    ds_write_b128 v4, v[96:99] offset:4096
    v_cvt_pk_bf16_f32 v72, v72, v73
    v_cvt_pk_bf16_f32 v73, v74, v75
    v_cvt_pk_bf16_f32 v74, v76, v77
    v_cvt_pk_bf16_f32 v75, v78, v79
    ds_write_b128 v5, v[72:75] offset:1024
    v_add_u32 v6, 104448, v7
    v_mov_b32 v5, 162304
    s_waitcnt lgkmcnt(0)
    s_barrier
    ds_read_b64_tr_b16 v[68:69], v7 offset:0
    ds_read_b64_tr_b16 v[70:71], v7 offset:144
    ds_read_b64_tr_b16 v[72:73], v7 offset:32
    ds_read_b64_tr_b16 v[74:75], v7 offset:176
    ds_read_b64_tr_b16 v[76:77], v7 offset:64
    ds_read_b64_tr_b16 v[78:79], v7 offset:208
    ds_read_b64_tr_b16 v[80:81], v7 offset:96
    ds_read_b64_tr_b16 v[82:83], v7 offset:240
    s_waitcnt lgkmcnt(6)
    v_mfma_f32_16x16x32_bf16 v[8:11], v[68:71], a[0:3], v[108:111]
    ds_read_b64_tr_b16 v[84:85], v7 offset:128
    v_mfma_f32_16x16x32_bf16 v[12:15], v[68:71], a[4:7], v[108:111]
    ds_read_b64_tr_b16 v[86:87], v7 offset:272
    s_waitcnt lgkmcnt(6)
    v_mfma_f32_16x16x32_bf16 v[16:19], v[72:75], a[0:3], v[108:111]
    ds_read_b64_tr_b16 v[88:89], v7 offset:4608
    v_mfma_f32_16x16x32_bf16 v[20:23], v[72:75], a[4:7], v[108:111]
    ds_read_b64_tr_b16 v[90:91], v7 offset:4752
    s_waitcnt lgkmcnt(6)
    v_mfma_f32_16x16x32_bf16 v[24:27], v[76:79], a[0:3], v[108:111]
    ds_read_b64_tr_b16 v[68:69], v7 offset:4640
    v_mfma_f32_16x16x32_bf16 v[28:31], v[76:79], a[4:7], v[108:111]
    ds_read_b64_tr_b16 v[70:71], v7 offset:4784
    s_waitcnt lgkmcnt(6)
    v_mfma_f32_16x16x32_bf16 v[32:35], v[80:83], a[0:3], v[108:111]
    ds_read_b64_tr_b16 v[72:73], v7 offset:4672
    v_mfma_f32_16x16x32_bf16 v[36:39], v[80:83], a[4:7], v[108:111]
    ds_read_b64_tr_b16 v[74:75], v7 offset:4816
    s_waitcnt lgkmcnt(6)
    v_mfma_f32_16x16x32_bf16 v[40:43], v[84:87], a[0:3], v[108:111]
    ds_read_b64_tr_b16 v[76:77], v7 offset:4704
    v_mfma_f32_16x16x32_bf16 v[44:47], v[84:87], a[4:7], v[108:111]
    ds_read_b64_tr_b16 v[78:79], v7 offset:4848
    s_waitcnt lgkmcnt(6)
    v_mfma_f32_16x16x32_bf16 v[8:11], v[88:91], a[8:11], v[8:11]
    ds_read_b64_tr_b16 v[80:81], v7 offset:4736
    v_mfma_f32_16x16x32_bf16 v[12:15], v[88:91], a[12:15], v[12:15]
    ds_read_b64_tr_b16 v[82:83], v7 offset:4880
    s_waitcnt lgkmcnt(6)
    v_mfma_f32_16x16x32_bf16 v[16:19], v[68:71], a[8:11], v[16:19]
    ds_read_b64_tr_b16 v[84:85], v7 offset:9216
    v_mfma_f32_16x16x32_bf16 v[20:23], v[68:71], a[12:15], v[20:23]
    ds_read_b64_tr_b16 v[86:87], v7 offset:9360
    s_waitcnt lgkmcnt(6)
    v_mfma_f32_16x16x32_bf16 v[24:27], v[72:75], a[8:11], v[24:27]
    ds_read_b64_tr_b16 v[88:89], v7 offset:9248
    v_mfma_f32_16x16x32_bf16 v[28:31], v[72:75], a[12:15], v[28:31]
    ds_read_b64_tr_b16 v[90:91], v7 offset:9392
    s_waitcnt lgkmcnt(6)
    v_mfma_f32_16x16x32_bf16 v[32:35], v[76:79], a[8:11], v[32:35]
    ds_read_b64_tr_b16 v[68:69], v7 offset:9280
    v_mfma_f32_16x16x32_bf16 v[36:39], v[76:79], a[12:15], v[36:39]
    ds_read_b64_tr_b16 v[70:71], v7 offset:9424
    s_waitcnt lgkmcnt(6)
    v_mfma_f32_16x16x32_bf16 v[40:43], v[80:83], a[8:11], v[40:43]
    ds_read_b64_tr_b16 v[72:73], v7 offset:9312
    v_mfma_f32_16x16x32_bf16 v[44:47], v[80:83], a[12:15], v[44:47]
    ds_read_b64_tr_b16 v[74:75], v7 offset:9456
    s_waitcnt lgkmcnt(6)
    v_mfma_f32_16x16x32_bf16 v[8:11], v[84:87], a[16:19], v[8:11]
    ds_read_b64_tr_b16 v[76:77], v7 offset:9344
    v_mfma_f32_16x16x32_bf16 v[12:15], v[84:87], a[20:23], v[12:15]
    ds_read_b64_tr_b16 v[78:79], v7 offset:9488
    s_waitcnt lgkmcnt(6)
    v_mfma_f32_16x16x32_bf16 v[16:19], v[88:91], a[16:19], v[16:19]
    ds_read_b64_tr_b16 v[80:81], v7 offset:13824
    v_mfma_f32_16x16x32_bf16 v[20:23], v[88:91], a[20:23], v[20:23]
    ds_read_b64_tr_b16 v[82:83], v7 offset:13968
    s_waitcnt lgkmcnt(6)
    v_mfma_f32_16x16x32_bf16 v[24:27], v[68:71], a[16:19], v[24:27]
    ds_read_b64_tr_b16 v[84:85], v7 offset:13856
    v_mfma_f32_16x16x32_bf16 v[28:31], v[68:71], a[20:23], v[28:31]
    ds_read_b64_tr_b16 v[86:87], v7 offset:14000
    s_waitcnt lgkmcnt(6)
    v_mfma_f32_16x16x32_bf16 v[32:35], v[72:75], a[16:19], v[32:35]
    ds_read_b64_tr_b16 v[88:89], v7 offset:13888
    v_mfma_f32_16x16x32_bf16 v[36:39], v[72:75], a[20:23], v[36:39]
    ds_read_b64_tr_b16 v[90:91], v7 offset:14032
    s_waitcnt lgkmcnt(6)
    v_mfma_f32_16x16x32_bf16 v[40:43], v[76:79], a[16:19], v[40:43]
    ds_read_b64_tr_b16 v[68:69], v7 offset:13920
    v_mfma_f32_16x16x32_bf16 v[44:47], v[76:79], a[20:23], v[44:47]
    ds_read_b64_tr_b16 v[70:71], v7 offset:14064
    s_waitcnt lgkmcnt(6)
    v_mfma_f32_16x16x32_bf16 v[8:11], v[80:83], a[24:27], v[8:11]
    ds_read_b64_tr_b16 v[72:73], v7 offset:13952
    v_mfma_f32_16x16x32_bf16 v[12:15], v[80:83], a[28:31], v[12:15]
    ds_read_b64_tr_b16 v[74:75], v7 offset:14096
    s_waitcnt lgkmcnt(6)
    v_mfma_f32_16x16x32_bf16 v[16:19], v[84:87], a[24:27], v[16:19]
    ds_read_b64_tr_b16 v[76:77], v7 offset:18432
    v_mfma_f32_16x16x32_bf16 v[20:23], v[84:87], a[28:31], v[20:23]
    ds_read_b64_tr_b16 v[78:79], v7 offset:18576
    s_waitcnt lgkmcnt(6)
    v_mfma_f32_16x16x32_bf16 v[24:27], v[88:91], a[24:27], v[24:27]
    ds_read_b64_tr_b16 v[80:81], v7 offset:18464
    v_mfma_f32_16x16x32_bf16 v[28:31], v[88:91], a[28:31], v[28:31]
    ds_read_b64_tr_b16 v[82:83], v7 offset:18608
    s_waitcnt lgkmcnt(6)
    v_mfma_f32_16x16x32_bf16 v[32:35], v[68:71], a[24:27], v[32:35]
    ds_read_b64_tr_b16 v[84:85], v7 offset:18496
    v_mfma_f32_16x16x32_bf16 v[36:39], v[68:71], a[28:31], v[36:39]
    ds_read_b64_tr_b16 v[86:87], v7 offset:18640
    s_waitcnt lgkmcnt(6)
    v_mfma_f32_16x16x32_bf16 v[40:43], v[72:75], a[24:27], v[40:43]
    ds_read_b64_tr_b16 v[88:89], v7 offset:18528
    v_mfma_f32_16x16x32_bf16 v[44:47], v[72:75], a[28:31], v[44:47]
    ds_read_b64_tr_b16 v[90:91], v7 offset:18672
    s_waitcnt lgkmcnt(6)
    v_mfma_f32_16x16x32_bf16 v[8:11], v[76:79], a[32:35], v[8:11]
    ds_read_b64_tr_b16 v[68:69], v7 offset:18560
    v_mfma_f32_16x16x32_bf16 v[12:15], v[76:79], a[36:39], v[12:15]
    ds_read_b64_tr_b16 v[70:71], v7 offset:18704
    s_waitcnt lgkmcnt(6)
    v_mfma_f32_16x16x32_bf16 v[16:19], v[80:83], a[32:35], v[16:19]
    ds_read_b64_tr_b16 v[72:73], v7 offset:23040
    v_mfma_f32_16x16x32_bf16 v[20:23], v[80:83], a[36:39], v[20:23]
    ds_read_b64_tr_b16 v[74:75], v7 offset:23184
    s_waitcnt lgkmcnt(6)
    v_mfma_f32_16x16x32_bf16 v[24:27], v[84:87], a[32:35], v[24:27]
    ds_read_b64_tr_b16 v[76:77], v7 offset:23072
    v_mfma_f32_16x16x32_bf16 v[28:31], v[84:87], a[36:39], v[28:31]
    ds_read_b64_tr_b16 v[78:79], v7 offset:23216
    s_waitcnt lgkmcnt(6)
    v_mfma_f32_16x16x32_bf16 v[32:35], v[88:91], a[32:35], v[32:35]
    ds_read_b64_tr_b16 v[80:81], v7 offset:23104
    v_mfma_f32_16x16x32_bf16 v[36:39], v[88:91], a[36:39], v[36:39]
    ds_read_b64_tr_b16 v[82:83], v7 offset:23248
    s_waitcnt lgkmcnt(6)
    v_mfma_f32_16x16x32_bf16 v[40:43], v[68:71], a[32:35], v[40:43]
    ds_read_b64_tr_b16 v[84:85], v7 offset:23136
    v_mfma_f32_16x16x32_bf16 v[44:47], v[68:71], a[36:39], v[44:47]
    ds_read_b64_tr_b16 v[86:87], v7 offset:23280
    s_waitcnt lgkmcnt(6)
    v_mfma_f32_16x16x32_bf16 v[8:11], v[72:75], a[40:43], v[8:11]
    ds_read_b64_tr_b16 v[88:89], v7 offset:23168
    v_mfma_f32_16x16x32_bf16 v[12:15], v[72:75], a[44:47], v[12:15]
    ds_read_b64_tr_b16 v[90:91], v7 offset:23312
    s_waitcnt lgkmcnt(6)
    v_mfma_f32_16x16x32_bf16 v[16:19], v[76:79], a[40:43], v[16:19]
    ds_read_b64_tr_b16 v[68:69], v7 offset:27648
    v_mfma_f32_16x16x32_bf16 v[20:23], v[76:79], a[44:47], v[20:23]
    ds_read_b64_tr_b16 v[70:71], v7 offset:27792
    s_waitcnt lgkmcnt(6)
    v_mfma_f32_16x16x32_bf16 v[24:27], v[80:83], a[40:43], v[24:27]
    ds_read_b64_tr_b16 v[72:73], v7 offset:27680
    v_mfma_f32_16x16x32_bf16 v[28:31], v[80:83], a[44:47], v[28:31]
    ds_read_b64_tr_b16 v[74:75], v7 offset:27824
    s_waitcnt lgkmcnt(6)
    v_mfma_f32_16x16x32_bf16 v[32:35], v[84:87], a[40:43], v[32:35]
    ds_read_b64_tr_b16 v[76:77], v7 offset:27712
    v_mfma_f32_16x16x32_bf16 v[36:39], v[84:87], a[44:47], v[36:39]
    ds_read_b64_tr_b16 v[78:79], v7 offset:27856
    s_waitcnt lgkmcnt(6)
    v_mfma_f32_16x16x32_bf16 v[40:43], v[88:91], a[40:43], v[40:43]
    ds_read_b64_tr_b16 v[80:81], v7 offset:27744
    v_mfma_f32_16x16x32_bf16 v[44:47], v[88:91], a[44:47], v[44:47]
    ds_read_b64_tr_b16 v[82:83], v7 offset:27888
    s_waitcnt lgkmcnt(6)
    v_mfma_f32_16x16x32_bf16 v[8:11], v[68:71], a[48:51], v[8:11]
    ds_read_b64_tr_b16 v[84:85], v7 offset:27776
    v_mfma_f32_16x16x32_bf16 v[12:15], v[68:71], a[52:55], v[12:15]
    ds_read_b64_tr_b16 v[86:87], v7 offset:27920
    s_waitcnt lgkmcnt(6)
    v_mfma_f32_16x16x32_bf16 v[16:19], v[72:75], a[48:51], v[16:19]
    ds_read_b64_tr_b16 v[88:89], v7 offset:32256
    v_mfma_f32_16x16x32_bf16 v[20:23], v[72:75], a[52:55], v[20:23]
    ds_read_b64_tr_b16 v[90:91], v7 offset:32400
    s_waitcnt lgkmcnt(6)
    v_mfma_f32_16x16x32_bf16 v[24:27], v[76:79], a[48:51], v[24:27]
    ds_read_b64_tr_b16 v[68:69], v7 offset:32288
    v_mfma_f32_16x16x32_bf16 v[28:31], v[76:79], a[52:55], v[28:31]
    ds_read_b64_tr_b16 v[70:71], v7 offset:32432
    s_waitcnt lgkmcnt(6)
    v_mfma_f32_16x16x32_bf16 v[32:35], v[80:83], a[48:51], v[32:35]
    ds_read_b64_tr_b16 v[72:73], v7 offset:32320
    v_mfma_f32_16x16x32_bf16 v[36:39], v[80:83], a[52:55], v[36:39]
    ds_read_b64_tr_b16 v[74:75], v7 offset:32464
    s_waitcnt lgkmcnt(6)
    v_mfma_f32_16x16x32_bf16 v[40:43], v[84:87], a[48:51], v[40:43]
    ds_read_b64_tr_b16 v[76:77], v7 offset:32352
    v_mfma_f32_16x16x32_bf16 v[44:47], v[84:87], a[52:55], v[44:47]
    ds_read_b64_tr_b16 v[78:79], v7 offset:32496
    s_waitcnt lgkmcnt(6)
    v_mfma_f32_16x16x32_bf16 v[8:11], v[88:91], a[56:59], v[8:11]
    ds_read_b64_tr_b16 v[80:81], v7 offset:32384
    v_mfma_f32_16x16x32_bf16 v[12:15], v[88:91], a[60:63], v[12:15]
    ds_read_b64_tr_b16 v[82:83], v7 offset:32528
    s_waitcnt lgkmcnt(6)
    v_mfma_f32_16x16x32_bf16 v[16:19], v[68:71], a[56:59], v[16:19]
    ds_read_b64_tr_b16 v[84:85], v7 offset:36864
    v_mfma_f32_16x16x32_bf16 v[20:23], v[68:71], a[60:63], v[20:23]
    ds_read_b64_tr_b16 v[86:87], v7 offset:37008
    s_waitcnt lgkmcnt(6)
    v_mfma_f32_16x16x32_bf16 v[24:27], v[72:75], a[56:59], v[24:27]
    ds_read_b64_tr_b16 v[88:89], v7 offset:36896
    v_mfma_f32_16x16x32_bf16 v[28:31], v[72:75], a[60:63], v[28:31]
    ds_read_b64_tr_b16 v[90:91], v7 offset:37040
    s_waitcnt lgkmcnt(6)
    v_mfma_f32_16x16x32_bf16 v[32:35], v[76:79], a[56:59], v[32:35]
    ds_read_b64_tr_b16 v[68:69], v7 offset:36928
    v_mfma_f32_16x16x32_bf16 v[36:39], v[76:79], a[60:63], v[36:39]
    ds_read_b64_tr_b16 v[70:71], v7 offset:37072
    s_waitcnt lgkmcnt(6)
    v_mfma_f32_16x16x32_bf16 v[40:43], v[80:83], a[56:59], v[40:43]
    ds_read_b64_tr_b16 v[72:73], v7 offset:36960
    v_mfma_f32_16x16x32_bf16 v[44:47], v[80:83], a[60:63], v[44:47]
    ds_read_b64_tr_b16 v[74:75], v7 offset:37104
    s_waitcnt lgkmcnt(6)
    v_mfma_f32_16x16x32_bf16 v[8:11], v[84:87], a[64:67], v[8:11]
    ds_read_b64_tr_b16 v[76:77], v7 offset:36992
    ds_read_b32 v92, v5 offset:4
    v_mfma_f32_16x16x32_bf16 v[12:15], v[84:87], a[68:71], v[12:15]
    ds_read_b64_tr_b16 v[78:79], v7 offset:37136
    s_waitcnt lgkmcnt(7)
    v_mfma_f32_16x16x32_bf16 v[16:19], v[88:91], a[64:67], v[16:19]
    ds_read_b64_tr_b16 v[80:81], v7 offset:41472
    v_mfma_f32_16x16x32_bf16 v[20:23], v[88:91], a[68:71], v[20:23]
    ds_read_b64_tr_b16 v[82:83], v7 offset:41616
    s_waitcnt lgkmcnt(7)
    v_mfma_f32_16x16x32_bf16 v[24:27], v[68:71], a[64:67], v[24:27]
    ds_read_b64_tr_b16 v[84:85], v7 offset:41504
    v_mfma_f32_16x16x32_bf16 v[28:31], v[68:71], a[68:71], v[28:31]
    ds_read_b64_tr_b16 v[86:87], v7 offset:41648
    s_waitcnt lgkmcnt(7)
    v_mfma_f32_16x16x32_bf16 v[32:35], v[72:75], a[64:67], v[32:35]
    ds_read_b64_tr_b16 v[88:89], v7 offset:41536
    v_mfma_f32_16x16x32_bf16 v[36:39], v[72:75], a[68:71], v[36:39]
    ds_read_b64_tr_b16 v[90:91], v7 offset:41680
    s_waitcnt lgkmcnt(6)
    v_mfma_f32_16x16x32_bf16 v[40:43], v[76:79], a[64:67], v[40:43]
    ds_read_b64_tr_b16 v[68:69], v7 offset:41568
    v_mfma_f32_16x16x32_bf16 v[44:47], v[76:79], a[68:71], v[44:47]
    ds_read_b64_tr_b16 v[70:71], v7 offset:41712
    s_waitcnt lgkmcnt(6)
    v_mfma_f32_16x16x32_bf16 v[8:11], v[80:83], a[72:75], v[8:11]
    ds_read_b64_tr_b16 v[72:73], v7 offset:41600
    v_mfma_f32_16x16x32_bf16 v[12:15], v[80:83], a[76:79], v[12:15]
    ds_read_b64_tr_b16 v[74:75], v7 offset:41744
    s_waitcnt lgkmcnt(6)
    v_mfma_f32_16x16x32_bf16 v[16:19], v[84:87], a[72:75], v[16:19]
    ds_read_b64_tr_b16 v[76:77], v7 offset:46080
    v_mfma_f32_16x16x32_bf16 v[20:23], v[84:87], a[76:79], v[20:23]
    ds_read_b64_tr_b16 v[78:79], v7 offset:46224
    s_waitcnt lgkmcnt(6)
    v_mfma_f32_16x16x32_bf16 v[24:27], v[88:91], a[72:75], v[24:27]
    ds_read_b64_tr_b16 v[80:81], v7 offset:46112
    v_mfma_f32_16x16x32_bf16 v[28:31], v[88:91], a[76:79], v[28:31]
    ds_read_b64_tr_b16 v[82:83], v7 offset:46256
    s_waitcnt lgkmcnt(6)
    v_mfma_f32_16x16x32_bf16 v[32:35], v[68:71], a[72:75], v[32:35]
    ds_read_b64_tr_b16 v[84:85], v7 offset:46144
    v_mfma_f32_16x16x32_bf16 v[36:39], v[68:71], a[76:79], v[36:39]
    ds_read_b64_tr_b16 v[86:87], v7 offset:46288
    s_waitcnt lgkmcnt(6)
    v_mfma_f32_16x16x32_bf16 v[40:43], v[72:75], a[72:75], v[40:43]
    ds_read_b64_tr_b16 v[88:89], v7 offset:46176
    v_mfma_f32_16x16x32_bf16 v[44:47], v[72:75], a[76:79], v[44:47]
    ds_read_b64_tr_b16 v[90:91], v7 offset:46320
    s_waitcnt lgkmcnt(6)
    v_mfma_f32_16x16x32_bf16 v[8:11], v[76:79], a[80:83], v[8:11]
    ds_read_b64_tr_b16 v[68:69], v7 offset:46208
    v_mfma_f32_16x16x32_bf16 v[12:15], v[76:79], a[84:87], v[12:15]
    ds_read_b64_tr_b16 v[70:71], v7 offset:46352
    s_waitcnt lgkmcnt(6)
    v_mfma_f32_16x16x32_bf16 v[16:19], v[80:83], a[80:83], v[16:19]
    ds_read_b64_tr_b16 v[72:73], v7 offset:50688
    v_mfma_f32_16x16x32_bf16 v[20:23], v[80:83], a[84:87], v[20:23]
    ds_read_b64_tr_b16 v[74:75], v7 offset:50832
    s_waitcnt lgkmcnt(6)
    v_mfma_f32_16x16x32_bf16 v[24:27], v[84:87], a[80:83], v[24:27]
    ds_read_b64_tr_b16 v[76:77], v7 offset:50720
    v_mfma_f32_16x16x32_bf16 v[28:31], v[84:87], a[84:87], v[28:31]
    ds_read_b64_tr_b16 v[78:79], v7 offset:50864
    s_waitcnt lgkmcnt(6)
    v_mfma_f32_16x16x32_bf16 v[32:35], v[88:91], a[80:83], v[32:35]
    ds_read_b64_tr_b16 v[80:81], v7 offset:50752
    v_mfma_f32_16x16x32_bf16 v[36:39], v[88:91], a[84:87], v[36:39]
    ds_read_b64_tr_b16 v[82:83], v7 offset:50896
    s_mov_b32 s44, 20000
L_b_wq:
    v_cmp_gt_u32 vcc, 4, v92
    s_nop 0
    s_cbranch_vccz L_b_wqok
    ds_read_b32 v92, v5 offset:4
    s_waitcnt lgkmcnt(0)
    s_sub_u32 s44, s44, 1
    s_nop 0
    s_cbranch_scc0 L_b_wq
L_b_wqok:
    s_waitcnt lgkmcnt(6)
    v_mfma_f32_16x16x32_bf16 v[40:43], v[68:71], a[80:83], v[40:43]
    ds_read_b64_tr_b16 v[84:85], v7 offset:50784
    v_mfma_f32_16x16x32_bf16 v[44:47], v[68:71], a[84:87], v[44:47]
    ds_read_b64_tr_b16 v[86:87], v7 offset:50928
    s_waitcnt lgkmcnt(6)
    v_mfma_f32_16x16x32_bf16 v[8:11], v[72:75], a[88:91], v[8:11]
    ds_read_b64_tr_b16 v[88:89], v7 offset:50816
    v_mfma_f32_16x16x32_bf16 v[12:15], v[72:75], a[92:95], v[12:15]
    ds_read_b64_tr_b16 v[90:91], v7 offset:50960
    s_waitcnt lgkmcnt(6)
    v_mfma_f32_16x16x32_bf16 v[16:19], v[76:79], a[88:91], v[16:19]
    ds_read_b64_tr_b16 v[68:69], v7 offset:55296
    v_mfma_f32_16x16x32_bf16 v[20:23], v[76:79], a[92:95], v[20:23]
    ds_read_b64_tr_b16 v[70:71], v7 offset:55440
    s_waitcnt lgkmcnt(6)
    v_mfma_f32_16x16x32_bf16 v[24:27], v[80:83], a[88:91], v[24:27]
    ds_read_b64_tr_b16 v[72:73], v7 offset:55328
    v_mfma_f32_16x16x32_bf16 v[28:31], v[80:83], a[92:95], v[28:31]
    ds_read_b64_tr_b16 v[74:75], v7 offset:55472
    s_waitcnt lgkmcnt(6)
    v_mfma_f32_16x16x32_bf16 v[32:35], v[84:87], a[88:91], v[32:35]
    ds_read_b64_tr_b16 v[76:77], v7 offset:55360
    v_mfma_f32_16x16x32_bf16 v[36:39], v[84:87], a[92:95], v[36:39]
    ds_read_b64_tr_b16 v[78:79], v7 offset:55504
    s_waitcnt lgkmcnt(6)
    v_mfma_f32_16x16x32_bf16 v[40:43], v[88:91], a[88:91], v[40:43]
    ds_read_b64_tr_b16 v[80:81], v7 offset:55392
    v_mfma_f32_16x16x32_bf16 v[44:47], v[88:91], a[92:95], v[44:47]
    ds_read_b64_tr_b16 v[82:83], v7 offset:55536
    s_waitcnt lgkmcnt(6)
    v_mfma_f32_16x16x32_bf16 v[8:11], v[68:71], a[96:99], v[8:11]
    ds_read_b64_tr_b16 v[84:85], v7 offset:55424
    v_mfma_f32_16x16x32_bf16 v[12:15], v[68:71], a[100:103], v[12:15]
    ds_read_b64_tr_b16 v[86:87], v7 offset:55568
    s_waitcnt lgkmcnt(6)
    v_mfma_f32_16x16x32_bf16 v[16:19], v[72:75], a[96:99], v[16:19]
    ds_read_b64_tr_b16 v[88:89], v7 offset:59904
    v_mfma_f32_16x16x32_bf16 v[20:23], v[72:75], a[100:103], v[20:23]
    ds_read_b64_tr_b16 v[90:91], v7 offset:60048
    s_waitcnt lgkmcnt(6)
    v_mfma_f32_16x16x32_bf16 v[24:27], v[76:79], a[96:99], v[24:27]
    ds_read_b64_tr_b16 v[68:69], v7 offset:59936
    v_mfma_f32_16x16x32_bf16 v[28:31], v[76:79], a[100:103], v[28:31]
    ds_read_b64_tr_b16 v[70:71], v7 offset:60080
    s_waitcnt lgkmcnt(6)
    v_mfma_f32_16x16x32_bf16 v[32:35], v[80:83], a[96:99], v[32:35]
    ds_read_b64_tr_b16 v[72:73], v7 offset:59968
    v_mfma_f32_16x16x32_bf16 v[36:39], v[80:83], a[100:103], v[36:39]
    ds_read_b64_tr_b16 v[74:75], v7 offset:60112
    s_waitcnt lgkmcnt(6)
    v_mfma_f32_16x16x32_bf16 v[40:43], v[84:87], a[96:99], v[40:43]
    ds_read_b64_tr_b16 v[76:77], v7 offset:60000
    v_mfma_f32_16x16x32_bf16 v[44:47], v[84:87], a[100:103], v[44:47]
    ds_read_b64_tr_b16 v[78:79], v7 offset:60144
    s_waitcnt lgkmcnt(6)
    v_mfma_f32_16x16x32_bf16 v[8:11], v[88:91], a[104:107], v[8:11]
    ds_read_b64_tr_b16 v[80:81], v7 offset:60032
    v_mfma_f32_16x16x32_bf16 v[12:15], v[88:91], a[108:111], v[12:15]
    ds_read_b64_tr_b16 v[82:83], v7 offset:60176
    s_waitcnt lgkmcnt(6)
    v_mfma_f32_16x16x32_bf16 v[16:19], v[68:71], a[104:107], v[16:19]
    ds_read_b64_tr_b16 v[84:85], v7 offset:64512
    v_mfma_f32_16x16x32_bf16 v[20:23], v[68:71], a[108:111], v[20:23]
    ds_read_b64_tr_b16 v[86:87], v7 offset:64656
    s_waitcnt lgkmcnt(6)
    v_mfma_f32_16x16x32_bf16 v[24:27], v[72:75], a[104:107], v[24:27]
    ds_read_b64_tr_b16 v[88:89], v7 offset:64544
    v_mfma_f32_16x16x32_bf16 v[28:31], v[72:75], a[108:111], v[28:31]
    ds_read_b64_tr_b16 v[90:91], v7 offset:64688
    s_waitcnt lgkmcnt(6)
    v_mfma_f32_16x16x32_bf16 v[32:35], v[76:79], a[104:107], v[32:35]
    ds_read_b64_tr_b16 v[68:69], v7 offset:64576
    v_mfma_f32_16x16x32_bf16 v[36:39], v[76:79], a[108:111], v[36:39]
    ds_read_b64_tr_b16 v[70:71], v7 offset:64720
    s_waitcnt lgkmcnt(6)
    v_mfma_f32_16x16x32_bf16 v[40:43], v[80:83], a[104:107], v[40:43]
    ds_read_b64_tr_b16 v[72:73], v7 offset:64608
    v_mfma_f32_16x16x32_bf16 v[44:47], v[80:83], a[108:111], v[44:47]
    ds_read_b64_tr_b16 v[74:75], v7 offset:64752
    s_waitcnt lgkmcnt(6)
    v_mfma_f32_16x16x32_bf16 v[8:11], v[84:87], a[112:115], v[8:11]
    ds_read_b64_tr_b16 v[76:77], v7 offset:64640
    v_mfma_f32_16x16x32_bf16 v[12:15], v[84:87], a[116:119], v[12:15]
    ds_read_b64_tr_b16 v[78:79], v7 offset:64784
    s_waitcnt lgkmcnt(6)
    v_mfma_f32_16x16x32_bf16 v[16:19], v[88:91], a[112:115], v[16:19]
    ds_read_b64_tr_b16 v[80:81], v6 offset:0
    v_mfma_f32_16x16x32_bf16 v[20:23], v[88:91], a[116:119], v[20:23]
    ds_read_b64_tr_b16 v[82:83], v6 offset:144
    s_waitcnt lgkmcnt(6)
    v_mfma_f32_16x16x32_bf16 v[24:27], v[68:71], a[112:115], v[24:27]
    ds_read_b64_tr_b16 v[84:85], v6 offset:32
    v_mfma_f32_16x16x32_bf16 v[28:31], v[68:71], a[116:119], v[28:31]
    ds_read_b64_tr_b16 v[86:87], v6 offset:176
    s_waitcnt lgkmcnt(6)
    v_mfma_f32_16x16x32_bf16 v[32:35], v[72:75], a[112:115], v[32:35]
    ds_read_b64_tr_b16 v[88:89], v6 offset:64
    v_mfma_f32_16x16x32_bf16 v[36:39], v[72:75], a[116:119], v[36:39]
    ds_read_b64_tr_b16 v[90:91], v6 offset:208
    s_waitcnt lgkmcnt(6)
    v_mfma_f32_16x16x32_bf16 v[40:43], v[76:79], a[112:115], v[40:43]
    ds_read_b64_tr_b16 v[68:69], v6 offset:96
    v_mfma_f32_16x16x32_bf16 v[44:47], v[76:79], a[116:119], v[44:47]
    ds_read_b64_tr_b16 v[70:71], v6 offset:240
    s_waitcnt lgkmcnt(6)
    v_mfma_f32_16x16x32_bf16 v[8:11], v[80:83], a[120:123], v[8:11]
    ds_read_b64_tr_b16 v[72:73], v6 offset:128
    v_mfma_f32_16x16x32_bf16 v[12:15], v[80:83], a[124:127], v[12:15]
    ds_read_b64_tr_b16 v[74:75], v6 offset:272
    s_waitcnt lgkmcnt(6)
    v_mfma_f32_16x16x32_bf16 v[16:19], v[84:87], a[120:123], v[16:19]
    ds_read_b64_tr_b16 v[76:77], v6 offset:4608
    v_mfma_f32_16x16x32_bf16 v[20:23], v[84:87], a[124:127], v[20:23]
    ds_read_b64_tr_b16 v[78:79], v6 offset:4752
    s_waitcnt lgkmcnt(6)
    v_mfma_f32_16x16x32_bf16 v[24:27], v[88:91], a[120:123], v[24:27]
    ds_read_b64_tr_b16 v[80:81], v6 offset:4640
    v_mfma_f32_16x16x32_bf16 v[28:31], v[88:91], a[124:127], v[28:31]
    ds_read_b64_tr_b16 v[82:83], v6 offset:4784
    s_waitcnt lgkmcnt(6)
    v_mfma_f32_16x16x32_bf16 v[32:35], v[68:71], a[120:123], v[32:35]
    ds_read_b64_tr_b16 v[84:85], v6 offset:4672
    v_mfma_f32_16x16x32_bf16 v[36:39], v[68:71], a[124:127], v[36:39]
    ds_read_b64_tr_b16 v[86:87], v6 offset:4816
    s_waitcnt lgkmcnt(6)
    v_mfma_f32_16x16x32_bf16 v[40:43], v[72:75], a[120:123], v[40:43]
    ds_read_b64_tr_b16 v[88:89], v6 offset:4704
    v_mfma_f32_16x16x32_bf16 v[44:47], v[72:75], a[124:127], v[44:47]
    ds_read_b64_tr_b16 v[90:91], v6 offset:4848
    s_waitcnt lgkmcnt(6)
    v_mfma_f32_16x16x32_bf16 v[8:11], v[76:79], a[128:131], v[8:11]
    ds_read_b64_tr_b16 v[68:69], v6 offset:4736
    v_mfma_f32_16x16x32_bf16 v[12:15], v[76:79], a[132:135], v[12:15]
    ds_read_b64_tr_b16 v[70:71], v6 offset:4880
    s_waitcnt lgkmcnt(6)
    v_mfma_f32_16x16x32_bf16 v[16:19], v[80:83], a[128:131], v[16:19]
    ds_read_b64_tr_b16 v[72:73], v6 offset:9216
    v_mfma_f32_16x16x32_bf16 v[20:23], v[80:83], a[132:135], v[20:23]
    ds_read_b64_tr_b16 v[74:75], v6 offset:9360
    s_waitcnt lgkmcnt(6)
    v_mfma_f32_16x16x32_bf16 v[24:27], v[84:87], a[128:131], v[24:27]
    ds_read_b64_tr_b16 v[76:77], v6 offset:9248
    v_mfma_f32_16x16x32_bf16 v[28:31], v[84:87], a[132:135], v[28:31]
    ds_read_b64_tr_b16 v[78:79], v6 offset:9392
    s_waitcnt lgkmcnt(6)
    v_mfma_f32_16x16x32_bf16 v[32:35], v[88:91], a[128:131], v[32:35]
    ds_read_b64_tr_b16 v[80:81], v6 offset:9280
    v_mfma_f32_16x16x32_bf16 v[36:39], v[88:91], a[132:135], v[36:39]
    ds_read_b64_tr_b16 v[82:83], v6 offset:9424
    s_waitcnt lgkmcnt(6)
    v_mfma_f32_16x16x32_bf16 v[40:43], v[68:71], a[128:131], v[40:43]
    ds_read_b64_tr_b16 v[84:85], v6 offset:9312
    v_mfma_f32_16x16x32_bf16 v[44:47], v[68:71], a[132:135], v[44:47]
    ds_read_b64_tr_b16 v[86:87], v6 offset:9456
    s_waitcnt lgkmcnt(6)
    v_mfma_f32_16x16x32_bf16 v[8:11], v[72:75], a[136:139], v[8:11]
    ds_read_b64_tr_b16 v[88:89], v6 offset:9344
    v_mfma_f32_16x16x32_bf16 v[12:15], v[72:75], a[140:143], v[12:15]
    ds_read_b64_tr_b16 v[90:91], v6 offset:9488
    s_waitcnt lgkmcnt(6)
    v_mfma_f32_16x16x32_bf16 v[16:19], v[76:79], a[136:139], v[16:19]
    v_mfma_f32_16x16x32_bf16 v[20:23], v[76:79], a[140:143], v[20:23]
    s_waitcnt lgkmcnt(4)
    v_mfma_f32_16x16x32_bf16 v[24:27], v[80:83], a[136:139], v[24:27]
    v_mfma_f32_16x16x32_bf16 v[28:31], v[80:83], a[140:143], v[28:31]
    s_waitcnt lgkmcnt(2)
    v_mfma_f32_16x16x32_bf16 v[32:35], v[84:87], a[136:139], v[32:35]
    v_mfma_f32_16x16x32_bf16 v[36:39], v[84:87], a[140:143], v[36:39]
    s_waitcnt lgkmcnt(0)
    v_mfma_f32_16x16x32_bf16 v[40:43], v[88:91], a[136:139], v[40:43]
    v_mfma_f32_16x16x32_bf16 v[44:47], v[88:91], a[140:143], v[44:47]
    v_pk_mul_f32 v[68:69], v[8:9], s[36:37]
    v_pk_mul_f32 v[72:73], v[10:11], s[36:37]
    v_pk_mul_f32 v[76:77], v[12:13], s[36:37]
    v_pk_mul_f32 v[80:81], v[14:15], s[36:37]
    v_max_f32 v70, s38, v8
    v_max_f32 v74, s38, v10
    v_max_f32 v78, s38, v12
    v_max_f32 v82, s38, v14
    v_exp_f32_e64 v68, v68 clamp
    v_exp_f32_e64 v72, v72 clamp
    v_exp_f32_e64 v76, v76 clamp
    v_exp_f32_e64 v80, v80 clamp
    v_exp_f32_e64 v69, v69 clamp
    v_exp_f32_e64 v73, v73 clamp
    v_exp_f32_e64 v77, v77 clamp
    v_exp_f32_e64 v81, v81 clamp
    v_max_f32 v71, s38, v9
    v_max_f32 v75, s38, v11
    v_max_f32 v79, s38, v13
    v_max_f32 v83, s38, v15
    v_pk_add_f32 v[68:69], v[68:69], v[70:71]
    v_pk_add_f32 v[72:73], v[72:73], v[74:75]
    v_pk_add_f32 v[76:77], v[76:77], v[78:79]
    v_pk_add_f32 v[80:81], v[80:81], v[82:83]
    v_cvt_pk_bf16_f32 v48, v68, v69
    v_cvt_pk_bf16_f32 v49, v72, v73
    v_cvt_pk_bf16_f32 v58, v76, v77
    v_cvt_pk_bf16_f32 v59, v80, v81
    v_pk_mul_f32 v[68:69], v[16:17], s[36:37]
    v_pk_mul_f32 v[72:73], v[18:19], s[36:37]
    v_pk_mul_f32 v[76:77], v[20:21], s[36:37]
    v_pk_mul_f32 v[80:81], v[22:23], s[36:37]
    v_max_f32 v70, s38, v16
    v_max_f32 v74, s38, v18
    v_max_f32 v78, s38, v20
    v_max_f32 v82, s38, v22
    v_exp_f32_e64 v68, v68 clamp
    v_exp_f32_e64 v72, v72 clamp
    v_exp_f32_e64 v76, v76 clamp
    v_exp_f32_e64 v80, v80 clamp
    v_exp_f32_e64 v69, v69 clamp
    v_exp_f32_e64 v73, v73 clamp
    v_exp_f32_e64 v77, v77 clamp
    v_exp_f32_e64 v81, v81 clamp
    v_max_f32 v71, s38, v17
    v_max_f32 v75, s38, v19
    v_max_f32 v79, s38, v21
    v_max_f32 v83, s38, v23
    v_pk_add_f32 v[68:69], v[68:69], v[70:71]
    v_pk_add_f32 v[72:73], v[72:73], v[74:75]
    v_pk_add_f32 v[76:77], v[76:77], v[78:79]
    v_pk_add_f32 v[80:81], v[80:81], v[82:83]
    v_cvt_pk_bf16_f32 v50, v68, v69
    v_cvt_pk_bf16_f32 v51, v72, v73
    v_cvt_pk_bf16_f32 v60, v76, v77
    v_cvt_pk_bf16_f32 v61, v80, v81
    v_pk_mul_f32 v[68:69], v[24:25], s[36:37]
    v_pk_mul_f32 v[72:73], v[26:27], s[36:37]
    v_pk_mul_f32 v[76:77], v[28:29], s[36:37]
    v_pk_mul_f32 v[80:81], v[30:31], s[36:37]
    v_max_f32 v70, s38, v24
    v_max_f32 v74, s38, v26
    v_max_f32 v78, s38, v28
    v_max_f32 v82, s38, v30
    v_exp_f32_e64 v68, v68 clamp
    v_exp_f32_e64 v72, v72 clamp
    v_exp_f32_e64 v76, v76 clamp
    v_exp_f32_e64 v80, v80 clamp
    v_exp_f32_e64 v69, v69 clamp
    v_exp_f32_e64 v73, v73 clamp
    v_exp_f32_e64 v77, v77 clamp
    v_exp_f32_e64 v81, v81 clamp
    v_max_f32 v71, s38, v25
    v_max_f32 v75, s38, v27
    v_max_f32 v79, s38, v29
    v_max_f32 v83, s38, v31
    v_pk_add_f32 v[68:69], v[68:69], v[70:71]
    v_pk_add_f32 v[72:73], v[72:73], v[74:75]
    v_pk_add_f32 v[76:77], v[76:77], v[78:79]
    v_pk_add_f32 v[80:81], v[80:81], v[82:83]
    v_cvt_pk_bf16_f32 v52, v68, v69
    v_cvt_pk_bf16_f32 v53, v72, v73
    v_cvt_pk_bf16_f32 v62, v76, v77
    v_cvt_pk_bf16_f32 v63, v80, v81
    v_pk_mul_f32 v[68:69], v[32:33], s[36:37]
    v_pk_mul_f32 v[72:73], v[34:35], s[36:37]
    v_pk_mul_f32 v[76:77], v[36:37], s[36:37]
    v_pk_mul_f32 v[80:81], v[38:39], s[36:37]
    v_max_f32 v70, s38, v32
    v_max_f32 v74, s38, v34
    v_max_f32 v78, s38, v36
    v_max_f32 v82, s38, v38
    v_exp_f32_e64 v68, v68 clamp
    v_exp_f32_e64 v72, v72 clamp
    v_exp_f32_e64 v76, v76 clamp
    v_exp_f32_e64 v80, v80 clamp
    v_exp_f32_e64 v69, v69 clamp
    v_exp_f32_e64 v73, v73 clamp
    v_exp_f32_e64 v77, v77 clamp
    v_exp_f32_e64 v81, v81 clamp
    v_max_f32 v71, s38, v33
    v_max_f32 v75, s38, v35
    v_max_f32 v79, s38, v37
    v_max_f32 v83, s38, v39
    v_pk_add_f32 v[68:69], v[68:69], v[70:71]
    v_pk_add_f32 v[72:73], v[72:73], v[74:75]
    v_pk_add_f32 v[76:77], v[76:77], v[78:79]
    v_pk_add_f32 v[80:81], v[80:81], v[82:83]
    v_cvt_pk_bf16_f32 v54, v68, v69
    v_cvt_pk_bf16_f32 v55, v72, v73
    v_cvt_pk_bf16_f32 v64, v76, v77
    v_cvt_pk_bf16_f32 v65, v80, v81
    v_pk_mul_f32 v[68:69], v[40:41], s[36:37]
    v_pk_mul_f32 v[72:73], v[42:43], s[36:37]
    v_pk_mul_f32 v[76:77], v[44:45], s[36:37]
    v_pk_mul_f32 v[80:81], v[46:47], s[36:37]
    v_max_f32 v70, s38, v40
    v_max_f32 v74, s38, v42
    v_max_f32 v78, s38, v44
    v_max_f32 v82, s38, v46
    v_exp_f32_e64 v68, v68 clamp
    v_exp_f32_e64 v72, v72 clamp
    v_exp_f32_e64 v76, v76 clamp
    v_exp_f32_e64 v80, v80 clamp
    v_exp_f32_e64 v69, v69 clamp
    v_exp_f32_e64 v73, v73 clamp
    v_exp_f32_e64 v77, v77 clamp
    v_exp_f32_e64 v81, v81 clamp
    v_max_f32 v71, s38, v41
    v_max_f32 v75, s38, v43
    v_max_f32 v79, s38, v45
    v_max_f32 v83, s38, v47
    v_pk_add_f32 v[68:69], v[68:69], v[70:71]
    v_pk_add_f32 v[72:73], v[72:73], v[74:75]
    v_pk_add_f32 v[76:77], v[76:77], v[78:79]
    v_pk_add_f32 v[80:81], v[80:81], v[82:83]
    v_cvt_pk_bf16_f32 v56, v68, v69
    v_cvt_pk_bf16_f32 v57, v72, v73
    v_cvt_pk_bf16_f32 v66, v76, v77
    v_cvt_pk_bf16_f32 v67, v80, v81
    v_lshlrev_b32 v4, 3, v1
    v_add_u32 v4, 153088, v4
    s_barrier
    ds_read_b64 a[26:27], v4 offset:6656
    ds_read_b64 a[28:29], v4 offset:7168
    ds_read_b64 a[30:31], v4 offset:7680
    ds_read_b64 a[32:33], v4 offset:8192
    ds_read_b64 a[34:35], v4 offset:8704
    ds_read_b64 a[0:1], v4 offset:0
    ds_read_b64 a[2:3], v4 offset:512
    ds_read_b64 a[4:5], v4 offset:1024
    ds_read_b64 a[6:7], v4 offset:1536
    ds_read_b64 a[8:9], v4 offset:2048
    ds_read_b64 a[10:11], v4 offset:2560
    ds_read_b64 a[12:13], v4 offset:3072
    ds_read_b64 a[14:15], v4 offset:3584
    ds_read_b64 a[16:17], v4 offset:4096
    ds_read_b64 a[18:19], v4 offset:4608
    ds_read_b64 a[20:21], v4 offset:5120
    ds_read_b64 a[22:23], v4 offset:5632
    ds_read_b64 a[24:25], v4 offset:6144
    s_waitcnt lgkmcnt(13)
    v_mfma_f32_16x16x32_bf16 v[68:71], a[26:29], v[48:51], v[108:111]
    v_mfma_f32_16x16x32_bf16 v[72:75], a[26:29], v[58:61], v[108:111]
    v_mfma_f32_16x16x32_bf16 v[68:71], a[30:33], v[52:55], v[68:71]
    v_mfma_f32_16x16x32_bf16 v[72:75], a[30:33], v[62:65], v[72:75]
    v_mfma_f32_16x16x16_bf16 v[68:71], a[34:35], v[56:57], v[68:71]
    v_mfma_f32_16x16x16_bf16 v[72:75], a[34:35], v[66:67], v[72:75]
    s_waitcnt lgkmcnt(0)
    v_mfma_f32_16x16x32_bf16 v[16:19], a[4:7], v[48:51], 0
    v_mfma_f32_16x16x32_bf16 v[24:27], a[10:13], v[50:53], 0
    v_mfma_f32_16x16x32_bf16 v[32:35], a[16:19], v[52:55], 0
    s_nop 2
    v_rcp_f32 v68, v68
    v_rcp_f32 v69, v69
    v_mfma_f32_16x16x32_bf16 v[8:11], a[0:3], v[48:51], 0
    v_rcp_f32 v70, v70
    v_rcp_f32 v71, v71
    v_mfma_f32_16x16x32_bf16 v[40:43], a[22:25], v[54:57], 0
    v_cndmask_b32 v76, v69, v68, s[42:43]
    v_cndmask_b32 v77, v69, v68, s[40:41]
    v_mfma_f32_16x16x16_bf16 v[16:19], a[8:9], v[52:53], v[16:19]
    v_cndmask_b32 v78, v70, v69, s[42:43]
    v_cndmask_b32 v79, v71, v70, s[42:43]
    v_mfma_f32_16x16x16_bf16 v[24:27], a[14:15], v[54:55], v[24:27]
    v_rcp_f32 v72, v72
    v_rcp_f32 v73, v73
    v_mfma_f32_16x16x16_bf16 v[32:35], a[20:21], v[56:57], v[32:35]
    v_rcp_f32 v74, v74
    v_rcp_f32 v75, v75
    v_mfma_f32_16x16x32_bf16 v[20:23], a[4:7], v[58:61], 0
    v_cndmask_b32 v80, v73, v72, s[42:43]
    v_cndmask_b32 v81, v73, v72, s[40:41]
    v_mfma_f32_16x16x32_bf16 v[28:31], a[10:13], v[60:63], 0
    v_cndmask_b32 v82, v74, v73, s[42:43]
    v_cndmask_b32 v83, v75, v74, s[42:43]
    v_mfma_f32_16x16x32_bf16 v[36:39], a[16:19], v[62:65], 0
    v_mfma_f32_16x16x32_bf16 v[12:15], a[0:3], v[58:61], 0
    v_mfma_f32_16x16x32_bf16 v[44:47], a[22:25], v[64:67], 0
    v_mfma_f32_16x16x16_bf16 v[20:23], a[8:9], v[62:63], v[20:23]
    v_mfma_f32_16x16x16_bf16 v[28:31], a[14:15], v[64:65], v[28:31]
    v_mfma_f32_16x16x16_bf16 v[36:39], a[20:21], v[66:67], v[36:39]
    v_pk_mul_f32 v[8:9], v[8:9], v[68:69] op_sel:[0,0] op_sel_hi:[1,0]
    v_pk_mul_f32 v[10:11], v[10:11], v[68:69] op_sel:[0,0] op_sel_hi:[1,0]
    v_pk_mul_f32 v[40:41], v[40:41], v[70:71] op_sel:[0,1] op_sel_hi:[1,1]
    v_pk_mul_f32 v[42:43], v[42:43], v[70:71] op_sel:[0,1] op_sel_hi:[1,1]
    v_pk_mul_f32 v[16:17], v[16:17], v[76:77] op_sel:[0,0] op_sel_hi:[1,0]
    v_pk_mul_f32 v[18:19], v[18:19], v[76:77] op_sel:[0,1] op_sel_hi:[1,1]
    v_pk_mul_f32 v[24:25], v[24:25], v[78:79] op_sel:[0,0] op_sel_hi:[1,0]
    v_pk_mul_f32 v[26:27], v[26:27], v[78:79] op_sel:[0,0] op_sel_hi:[1,0]
    v_pk_mul_f32 v[32:33], v[32:33], v[70:71] op_sel:[0,0] op_sel_hi:[1,0]
    v_pk_mul_f32 v[34:35], v[34:35], v[78:79] op_sel:[0,1] op_sel_hi:[1,1]
    v_cvt_pk_bf16_f32 v56, v8, v9
    v_cvt_pk_bf16_f32 v57, v10, v11
    v_cvt_pk_bf16_f32 v54, v40, v41
    v_cvt_pk_bf16_f32 v55, v42, v43
    v_cvt_pk_bf16_f32 v48, v16, v17
    v_cvt_pk_bf16_f32 v49, v18, v19
    v_cvt_pk_bf16_f32 v50, v24, v25
    v_cvt_pk_bf16_f32 v51, v26, v27
    v_cvt_pk_bf16_f32 v52, v32, v33
    v_cvt_pk_bf16_f32 v53, v34, v35
    v_min_u32 v48, -2, v48
    v_min_u32 v52, -2, v52
    v_min_u32 v56, -2, v56
    buffer_store_dwordx4 v[48:51], v105, s[16:19], s20 offen sc1
    buffer_store_dwordx4 v[52:55], v105, s[16:19], s20 offen offset:1024 sc1
    v_pk_mul_f32 v[12:13], v[12:13], v[72:73] op_sel:[0,0] op_sel_hi:[1,0]
    v_pk_mul_f32 v[14:15], v[14:15], v[72:73] op_sel:[0,0] op_sel_hi:[1,0]
    v_pk_mul_f32 v[44:45], v[44:45], v[74:75] op_sel:[0,1] op_sel_hi:[1,1]
    v_pk_mul_f32 v[46:47], v[46:47], v[74:75] op_sel:[0,1] op_sel_hi:[1,1]
    v_pk_mul_f32 v[20:21], v[20:21], v[80:81] op_sel:[0,0] op_sel_hi:[1,0]
    v_pk_mul_f32 v[22:23], v[22:23], v[80:81] op_sel:[0,1] op_sel_hi:[1,1]
    v_pk_mul_f32 v[28:29], v[28:29], v[82:83] op_sel:[0,0] op_sel_hi:[1,0]
    v_pk_mul_f32 v[30:31], v[30:31], v[82:83] op_sel:[0,0] op_sel_hi:[1,0]
    v_pk_mul_f32 v[36:37], v[36:37], v[74:75] op_sel:[0,0] op_sel_hi:[1,0]
    v_pk_mul_f32 v[38:39], v[38:39], v[82:83] op_sel:[0,1] op_sel_hi:[1,1]
    v_cvt_pk_bf16_f32 v66, v12, v13
    v_cvt_pk_bf16_f32 v67, v14, v15
    v_cvt_pk_bf16_f32 v64, v44, v45
    v_cvt_pk_bf16_f32 v65, v46, v47
    v_cvt_pk_bf16_f32 v58, v20, v21
    v_cvt_pk_bf16_f32 v59, v22, v23
    v_cvt_pk_bf16_f32 v60, v28, v29
    v_cvt_pk_bf16_f32 v61, v30, v31
    v_cvt_pk_bf16_f32 v62, v36, v37
    v_cvt_pk_bf16_f32 v63, v38, v39
    v_min_u32 v58, -2, v58
    v_min_u32 v62, -2, v62
    v_min_u32 v66, -2, v66
    buffer_store_dwordx4 v[58:61], v106, s[16:19], s20 offen sc1
    buffer_store_dwordx4 v[62:65], v106, s[16:19], s20 offen offset:1024 sc1
    s_mov_b32 exec_lo, 0
    buffer_store_dwordx2 v[56:57], v104, s[16:19], 0 offen sc1
    buffer_store_dwordx2 v[66:67], v104, s[16:19], s21 offen sc1
    s_mov_b32 exec_lo, -1
    v_subrev_u32 v7, 34816, v7
    v_add_u32 v6, 104448, v7
    s_mov_b32 s39, 0
    s_movk_i32 s23, 16384
    s_barrier
L_b_gemm2:
    ds_read_b64_tr_b16 v[72:73], v7 offset:0
    ds_read_b64_tr_b16 v[74:75], v7 offset:144
    ds_read_b64_tr_b16 v[76:77], v7 offset:32
    ds_read_b64_tr_b16 v[78:79], v7 offset:176
    ds_read_b64_tr_b16 v[80:81], v7 offset:64
    ds_read_b64_tr_b16 v[82:83], v7 offset:208
    ds_read_b64_tr_b16 v[84:85], v7 offset:96
    ds_read_b64_tr_b16 v[86:87], v7 offset:240
    ds_read_b64_tr_b16 v[88:89], v7 offset:128
    ds_read_b64_tr_b16 v[90:91], v7 offset:272
    s_waitcnt lgkmcnt(8)
    v_mfma_f32_16x16x32_bf16 v[8:11], v[72:75], v[48:51], 0
    ds_read_b64_tr_b16 v[92:93], v7 offset:4608
    v_mfma_f32_16x16x32_bf16 v[12:15], v[72:75], v[58:61], 0
    ds_read_b64_tr_b16 v[94:95], v7 offset:4752
    s_waitcnt lgkmcnt(8)
    v_mfma_f32_16x16x32_bf16 v[16:19], v[76:79], v[48:51], 0
    ds_read_b64_tr_b16 v[96:97], v7 offset:4640
    v_mfma_f32_16x16x32_bf16 v[20:23], v[76:79], v[58:61], 0
    ds_read_b64_tr_b16 v[98:99], v7 offset:4784
    s_waitcnt lgkmcnt(8)
    v_mfma_f32_16x16x32_bf16 v[24:27], v[80:83], v[48:51], 0
    ds_read_b64_tr_b16 v[100:101], v7 offset:4672
    v_mfma_f32_16x16x32_bf16 v[28:31], v[80:83], v[58:61], 0
    ds_read_b64_tr_b16 v[102:103], v7 offset:4816
    s_waitcnt lgkmcnt(8)
    v_mfma_f32_16x16x32_bf16 v[32:35], v[84:87], v[48:51], 0
    ds_read_b64_tr_b16 v[72:73], v7 offset:4704
    v_mfma_f32_16x16x32_bf16 v[36:39], v[84:87], v[58:61], 0
    ds_read_b64_tr_b16 v[74:75], v7 offset:4848
    s_waitcnt lgkmcnt(8)
    v_mfma_f32_16x16x32_bf16 v[40:43], v[88:91], v[48:51], 0
    ds_read_b64_tr_b16 v[76:77], v7 offset:4736
    v_mfma_f32_16x16x32_bf16 v[44:47], v[88:91], v[58:61], 0
    ds_read_b64_tr_b16 v[78:79], v7 offset:4880
    s_waitcnt lgkmcnt(8)
    v_mfma_f32_16x16x32_bf16 v[8:11], v[92:95], v[52:55], v[8:11]
    ds_read_b64_tr_b16 v[80:81], v7 offset:9216
    v_mfma_f32_16x16x32_bf16 v[12:15], v[92:95], v[62:65], v[12:15]
    ds_read_b64_tr_b16 v[82:83], v7 offset:9360
    s_waitcnt lgkmcnt(8)
    v_mfma_f32_16x16x32_bf16 v[16:19], v[96:99], v[52:55], v[16:19]
    ds_read_b64_tr_b16 v[84:85], v7 offset:9248
    v_mfma_f32_16x16x32_bf16 v[20:23], v[96:99], v[62:65], v[20:23]
    ds_read_b64_tr_b16 v[86:87], v7 offset:9392
    s_waitcnt lgkmcnt(8)
    v_mfma_f32_16x16x32_bf16 v[24:27], v[100:103], v[52:55], v[24:27]
    ds_read_b64_tr_b16 v[88:89], v7 offset:9280
    v_mfma_f32_16x16x32_bf16 v[28:31], v[100:103], v[62:65], v[28:31]
    ds_read_b64_tr_b16 v[90:91], v7 offset:9424
    s_waitcnt lgkmcnt(8)
    v_mfma_f32_16x16x32_bf16 v[32:35], v[72:75], v[52:55], v[32:35]
    ds_read_b64_tr_b16 v[92:93], v7 offset:9312
    v_mfma_f32_16x16x32_bf16 v[36:39], v[72:75], v[62:65], v[36:39]
    ds_read_b64_tr_b16 v[94:95], v7 offset:9456
    s_waitcnt lgkmcnt(8)
    v_mfma_f32_16x16x32_bf16 v[40:43], v[76:79], v[52:55], v[40:43]
    ds_read_b64_tr_b16 v[96:97], v7 offset:9344
    v_mfma_f32_16x16x32_bf16 v[44:47], v[76:79], v[62:65], v[44:47]
    ds_read_b64_tr_b16 v[98:99], v7 offset:9488
    s_lshl_b32 s32, s25, 7
    s_lshl_b32 s33, s24, 5
    s_add_u32 s32, s32, s33
    s_mul_i32 s32, s32, 2304
    s_mul_i32 s33, s26, 144
    s_add_u32 s32, s32, s33
    s_add_u32 s32, s32, 1152
    v_add_u32 v48, 0, v1
    v_mul_u32_u24 v49, 7282, v48
    v_lshrrev_b32 v49, 16, v49
    v_mul_u32_u24 v51, 9, v49
    v_sub_u32 v50, v48, v51
    v_mul_u32_u24 v49, 2304, v49
    v_lshl_add_u32 v49, v50, 4, v49
    v_add_u32 v108, s32, v49
    v_add_u32 v48, 64, v1
    v_mul_u32_u24 v49, 7282, v48
    v_lshrrev_b32 v49, 16, v49
    v_mul_u32_u24 v51, 9, v49
    v_sub_u32 v50, v48, v51
    v_mul_u32_u24 v49, 2304, v49
    v_lshl_add_u32 v49, v50, 4, v49
    v_add_u32 v109, s32, v49
    v_add_u32 v48, 128, v1
    v_mul_u32_u24 v49, 7282, v48
    v_lshrrev_b32 v49, 16, v49
    v_mul_u32_u24 v51, 9, v49
    v_sub_u32 v50, v48, v51
    v_mul_u32_u24 v49, 2304, v49
    v_lshl_add_u32 v49, v50, 4, v49
    v_add_u32 v110, s32, v49
    v_add_u32 v48, 192, v1
    v_mul_u32_u24 v49, 7282, v48
    v_lshrrev_b32 v49, 16, v49
    v_mul_u32_u24 v51, 9, v49
    v_sub_u32 v50, v48, v51
    v_mul_u32_u24 v49, 2304, v49
    v_lshl_add_u32 v49, v50, 4, v49
    v_add_u32 v111, s32, v49
    v_add_u32 v48, 256, v1
    v_mul_u32_u24 v49, 7282, v48
    v_lshrrev_b32 v49, 16, v49
    v_mul_u32_u24 v51, 9, v49
    v_sub_u32 v50, v48, v51
    v_mul_u32_u24 v49, 2304, v49
    v_lshl_add_u32 v49, v50, 4, v49
    v_add_u32 v104, s32, v49
    s_mul_i32 s33, s24, 4608
    s_add_u32 s33, s33, 57856
    v_mul_u32_u24 v4, 144, v2
    v_lshl_add_u32 v4, v3, 3, v4
    v_add_u32 v4, s33, v4
    v_lshl_add_u32 v5, v1, 4, s33
    s_mov_b32 s44, 20000
    v_lshlrev_b32 v107, 8, v1
    v_lshlrev_b32 v48, 4, v1
    v_sub_u32 v107, v107, v48
    v_add_u32 v107, v107, v106
    s_mov_b64 exec, 0xff
L_b_probe:
    buffer_load_dword v68, v107, s[16:19], s23 offen offset:248 sc1
    s_sub_u32 s44, s44, 1
    s_cbranch_scc1 L_b_probed
    s_waitcnt vmcnt(0)
    v_cmp_eq_u32 vcc, -1, v68
    s_nop 0
    s_nop 0
    s_cbranch_vccnz L_b_probe
L_b_probed:
    s_mov_b64 exec, -1
    buffer_load_dwordx4 a[16:19], v105, s[16:19], s45 offen sc1
    buffer_load_dwordx4 a[20:23], v106, s[16:19], s45 offen sc1
    buffer_load_dwordx4 a[24:27], v105, s[16:19], s45 offen offset:1024 sc1
    buffer_load_dwordx4 a[28:31], v106, s[16:19], s45 offen offset:1024 sc1
    buffer_load_dwordx4 a[32:35], v105, s[16:19], s46 offen sc1
    buffer_load_dwordx4 a[36:39], v106, s[16:19], s46 offen sc1
    buffer_load_dwordx4 a[40:43], v105, s[16:19], s46 offen offset:1024 sc1
    buffer_load_dwordx4 a[44:47], v106, s[16:19], s46 offen offset:1024 sc1
    s_waitcnt vmcnt(6) lgkmcnt(8)
    v_mfma_f32_16x16x32_bf16 v[8:11], v[80:83], a[16:19], v[8:11]
    ds_read_b64_tr_b16 v[100:101], v7 offset:13824
    buffer_load_dwordx4 a[48:51], v105, s[16:19], s47 offen sc1
    v_mfma_f32_16x16x32_bf16 v[12:15], v[80:83], a[20:23], v[12:15]
    ds_read_b64_tr_b16 v[102:103], v7 offset:13968
    s_waitcnt lgkmcnt(8)
    v_mfma_f32_16x16x32_bf16 v[16:19], v[84:87], a[16:19], v[16:19]
    ds_read_b64_tr_b16 v[72:73], v7 offset:13856
    buffer_load_dwordx4 a[52:55], v106, s[16:19], s47 offen sc1
    v_mfma_f32_16x16x32_bf16 v[20:23], v[84:87], a[20:23], v[20:23]
    ds_read_b64_tr_b16 v[74:75], v7 offset:14000
    s_waitcnt lgkmcnt(8)
    v_mfma_f32_16x16x32_bf16 v[24:27], v[88:91], a[16:19], v[24:27]
    ds_read_b64_tr_b16 v[76:77], v7 offset:13888
    buffer_load_dwordx4 a[56:59], v105, s[16:19], s47 offen offset:1024 sc1
    v_mfma_f32_16x16x32_bf16 v[28:31], v[88:91], a[20:23], v[28:31]
    ds_read_b64_tr_b16 v[78:79], v7 offset:14032
    s_waitcnt lgkmcnt(8)
    v_mfma_f32_16x16x32_bf16 v[32:35], v[92:95], a[16:19], v[32:35]
    ds_read_b64_tr_b16 v[80:81], v7 offset:13920
    buffer_load_dwordx4 a[60:63], v106, s[16:19], s47 offen offset:1024 sc1
    v_mfma_f32_16x16x32_bf16 v[36:39], v[92:95], a[20:23], v[36:39]
    ds_read_b64_tr_b16 v[82:83], v7 offset:14064
    s_waitcnt lgkmcnt(8)
    v_mfma_f32_16x16x32_bf16 v[40:43], v[96:99], a[16:19], v[40:43]
    ds_read_b64_tr_b16 v[84:85], v7 offset:13952
    v_mfma_f32_16x16x32_bf16 v[44:47], v[96:99], a[20:23], v[44:47]
    ds_read_b64_tr_b16 v[86:87], v7 offset:14096
    s_waitcnt vmcnt(8) lgkmcnt(8)
    v_mfma_f32_16x16x32_bf16 v[8:11], v[100:103], a[24:27], v[8:11]
    ds_read_b64_tr_b16 v[88:89], v7 offset:18432
    buffer_load_dwordx4 a[64:67], v105, s[16:19], s48 offen sc1
    v_mfma_f32_16x16x32_bf16 v[12:15], v[100:103], a[28:31], v[12:15]
    ds_read_b64_tr_b16 v[90:91], v7 offset:18576
    s_waitcnt lgkmcnt(8)
    v_mfma_f32_16x16x32_bf16 v[16:19], v[72:75], a[24:27], v[16:19]
    ds_read_b64_tr_b16 v[92:93], v7 offset:18464
    buffer_load_dwordx4 a[68:71], v106, s[16:19], s48 offen sc1
    v_mfma_f32_16x16x32_bf16 v[20:23], v[72:75], a[28:31], v[20:23]
    ds_read_b64_tr_b16 v[94:95], v7 offset:18608
    s_waitcnt lgkmcnt(8)
    v_mfma_f32_16x16x32_bf16 v[24:27], v[76:79], a[24:27], v[24:27]
    ds_read_b64_tr_b16 v[96:97], v7 offset:18496
    buffer_load_dwordx4 a[72:75], v105, s[16:19], s48 offen offset:1024 sc1
    v_mfma_f32_16x16x32_bf16 v[28:31], v[76:79], a[28:31], v[28:31]
    ds_read_b64_tr_b16 v[98:99], v7 offset:18640
    s_waitcnt lgkmcnt(8)
    v_mfma_f32_16x16x32_bf16 v[32:35], v[80:83], a[24:27], v[32:35]
    ds_read_b64_tr_b16 v[100:101], v7 offset:18528
    buffer_load_dwordx4 a[76:79], v106, s[16:19], s48 offen offset:1024 sc1
    v_mfma_f32_16x16x32_bf16 v[36:39], v[80:83], a[28:31], v[36:39]
    ds_read_b64_tr_b16 v[102:103], v7 offset:18672
    s_waitcnt lgkmcnt(8)
    v_mfma_f32_16x16x32_bf16 v[40:43], v[84:87], a[24:27], v[40:43]
    ds_read_b64_tr_b16 v[72:73], v7 offset:18560
    v_mfma_f32_16x16x32_bf16 v[44:47], v[84:87], a[28:31], v[44:47]
    ds_read_b64_tr_b16 v[74:75], v7 offset:18704
    s_waitcnt vmcnt(10) lgkmcnt(8)
    v_mfma_f32_16x16x32_bf16 v[8:11], v[88:91], a[32:35], v[8:11]
    ds_read_b64_tr_b16 v[76:77], v7 offset:23040
    buffer_load_dwordx4 a[80:83], v105, s[16:19], s49 offen sc1
    v_mfma_f32_16x16x32_bf16 v[12:15], v[88:91], a[36:39], v[12:15]
    ds_read_b64_tr_b16 v[78:79], v7 offset:23184
    s_waitcnt lgkmcnt(8)
    v_mfma_f32_16x16x32_bf16 v[16:19], v[92:95], a[32:35], v[16:19]
    ds_read_b64_tr_b16 v[80:81], v7 offset:23072
    buffer_load_dwordx4 a[84:87], v106, s[16:19], s49 offen sc1
    v_mfma_f32_16x16x32_bf16 v[20:23], v[92:95], a[36:39], v[20:23]
    ds_read_b64_tr_b16 v[82:83], v7 offset:23216
    s_waitcnt lgkmcnt(8)
    v_mfma_f32_16x16x32_bf16 v[24:27], v[96:99], a[32:35], v[24:27]
    ds_read_b64_tr_b16 v[84:85], v7 offset:23104
    buffer_load_dwordx4 a[88:91], v105, s[16:19], s49 offen offset:1024 sc1
    v_mfma_f32_16x16x32_bf16 v[28:31], v[96:99], a[36:39], v[28:31]
    ds_read_b64_tr_b16 v[86:87], v7 offset:23248
    s_waitcnt lgkmcnt(8)
    v_mfma_f32_16x16x32_bf16 v[32:35], v[100:103], a[32:35], v[32:35]
    ds_read_b64_tr_b16 v[88:89], v7 offset:23136
    buffer_load_dwordx4 a[92:95], v106, s[16:19], s49 offen offset:1024 sc1
    v_mfma_f32_16x16x32_bf16 v[36:39], v[100:103], a[36:39], v[36:39]
    ds_read_b64_tr_b16 v[90:91], v7 offset:23280
    s_waitcnt lgkmcnt(8)
    v_mfma_f32_16x16x32_bf16 v[40:43], v[72:75], a[32:35], v[40:43]
    ds_read_b64_tr_b16 v[92:93], v7 offset:23168
    v_mfma_f32_16x16x32_bf16 v[44:47], v[72:75], a[36:39], v[44:47]
    ds_read_b64_tr_b16 v[94:95], v7 offset:23312
    s_waitcnt vmcnt(12) lgkmcnt(8)
    v_mfma_f32_16x16x32_bf16 v[8:11], v[76:79], a[40:43], v[8:11]
    ds_read_b64_tr_b16 v[96:97], v6 offset:0
    v_mfma_f32_16x16x32_bf16 v[12:15], v[76:79], a[44:47], v[12:15]
    ds_read_b64_tr_b16 v[98:99], v6 offset:144
    s_waitcnt lgkmcnt(8)
    v_mfma_f32_16x16x32_bf16 v[16:19], v[80:83], a[40:43], v[16:19]
    ds_read_b64_tr_b16 v[100:101], v6 offset:32
    buffer_load_dwordx4 a[96:99], v105, s[16:19], s50 offen sc1
    v_mfma_f32_16x16x32_bf16 v[20:23], v[80:83], a[44:47], v[20:23]
    ds_read_b64_tr_b16 v[102:103], v6 offset:176
    s_waitcnt lgkmcnt(8)
    v_mfma_f32_16x16x32_bf16 v[24:27], v[84:87], a[40:43], v[24:27]
    ds_read_b64_tr_b16 v[72:73], v6 offset:64
    v_mfma_f32_16x16x32_bf16 v[28:31], v[84:87], a[44:47], v[28:31]
    ds_read_b64_tr_b16 v[74:75], v6 offset:208
    s_waitcnt lgkmcnt(8)
    v_mfma_f32_16x16x32_bf16 v[32:35], v[88:91], a[40:43], v[32:35]
    ds_read_b64_tr_b16 v[76:77], v6 offset:96
    buffer_load_dwordx4 a[100:103], v106, s[16:19], s50 offen sc1
    v_mfma_f32_16x16x32_bf16 v[36:39], v[88:91], a[44:47], v[36:39]
    ds_read_b64_tr_b16 v[78:79], v6 offset:240
    s_waitcnt lgkmcnt(8)
    v_mfma_f32_16x16x32_bf16 v[40:43], v[92:95], a[40:43], v[40:43]
    ds_read_b64_tr_b16 v[80:81], v6 offset:128
    v_mfma_f32_16x16x32_bf16 v[44:47], v[92:95], a[44:47], v[44:47]
    ds_read_b64_tr_b16 v[82:83], v6 offset:272
    s_waitcnt vmcnt(12) lgkmcnt(8)
    v_mfma_f32_16x16x32_bf16 v[8:11], v[96:99], a[48:51], v[8:11]
    ds_read_b64_tr_b16 v[84:85], v6 offset:4608
    v_mfma_f32_16x16x32_bf16 v[12:15], v[96:99], a[52:55], v[12:15]
    ds_read_b64_tr_b16 v[86:87], v6 offset:4752
    s_waitcnt lgkmcnt(8)
    v_mfma_f32_16x16x32_bf16 v[16:19], v[100:103], a[48:51], v[16:19]
    ds_read_b64_tr_b16 v[88:89], v6 offset:4640
    buffer_load_dwordx4 a[104:107], v105, s[16:19], s50 offen offset:1024 sc1
    v_mfma_f32_16x16x32_bf16 v[20:23], v[100:103], a[52:55], v[20:23]
    ds_read_b64_tr_b16 v[90:91], v6 offset:4784
    s_waitcnt lgkmcnt(8)
    v_mfma_f32_16x16x32_bf16 v[24:27], v[72:75], a[48:51], v[24:27]
    ds_read_b64_tr_b16 v[92:93], v6 offset:4672
    v_mfma_f32_16x16x32_bf16 v[28:31], v[72:75], a[52:55], v[28:31]
    ds_read_b64_tr_b16 v[94:95], v6 offset:4816
    s_waitcnt lgkmcnt(8)
    v_mfma_f32_16x16x32_bf16 v[32:35], v[76:79], a[48:51], v[32:35]
    ds_read_b64_tr_b16 v[96:97], v6 offset:4704
    buffer_load_dwordx4 a[108:111], v106, s[16:19], s50 offen offset:1024 sc1
    v_mfma_f32_16x16x32_bf16 v[36:39], v[76:79], a[52:55], v[36:39]
    ds_read_b64_tr_b16 v[98:99], v6 offset:4848
    s_waitcnt lgkmcnt(8)
    v_mfma_f32_16x16x32_bf16 v[40:43], v[80:83], a[48:51], v[40:43]
    ds_read_b64_tr_b16 v[100:101], v6 offset:4736
    v_mfma_f32_16x16x32_bf16 v[44:47], v[80:83], a[52:55], v[44:47]
    ds_read_b64_tr_b16 v[102:103], v6 offset:4880
    s_waitcnt vmcnt(12) lgkmcnt(8)
    v_mfma_f32_16x16x32_bf16 v[8:11], v[84:87], a[56:59], v[8:11]
    ds_read_b64_tr_b16 v[72:73], v6 offset:9216
    v_mfma_f32_16x16x32_bf16 v[12:15], v[84:87], a[60:63], v[12:15]
    ds_read_b64_tr_b16 v[74:75], v6 offset:9360
    s_waitcnt lgkmcnt(8)
    v_mfma_f32_16x16x32_bf16 v[16:19], v[88:91], a[56:59], v[16:19]
    ds_read_b64_tr_b16 v[76:77], v6 offset:9248
    buffer_load_dwordx4 a[112:115], v105, s[16:19], s51 offen sc1
    v_mfma_f32_16x16x32_bf16 v[20:23], v[88:91], a[60:63], v[20:23]
    ds_read_b64_tr_b16 v[78:79], v6 offset:9392
    s_waitcnt lgkmcnt(8)
    v_mfma_f32_16x16x32_bf16 v[24:27], v[92:95], a[56:59], v[24:27]
    ds_read_b64_tr_b16 v[80:81], v6 offset:9280
    v_mfma_f32_16x16x32_bf16 v[28:31], v[92:95], a[60:63], v[28:31]
    ds_read_b64_tr_b16 v[82:83], v6 offset:9424
    s_waitcnt lgkmcnt(8)
    v_mfma_f32_16x16x32_bf16 v[32:35], v[96:99], a[56:59], v[32:35]
    ds_read_b64_tr_b16 v[84:85], v6 offset:9312
    buffer_load_dwordx4 a[116:119], v106, s[16:19], s51 offen sc1
    v_mfma_f32_16x16x32_bf16 v[36:39], v[96:99], a[60:63], v[36:39]
    ds_read_b64_tr_b16 v[86:87], v6 offset:9456
    s_waitcnt lgkmcnt(8)
    v_mfma_f32_16x16x32_bf16 v[40:43], v[100:103], a[56:59], v[40:43]
    ds_read_b64_tr_b16 v[88:89], v6 offset:9344
    v_mfma_f32_16x16x32_bf16 v[44:47], v[100:103], a[60:63], v[44:47]
    ds_read_b64_tr_b16 v[90:91], v6 offset:9488
    s_waitcnt vmcnt(12) lgkmcnt(8)
    v_mfma_f32_16x16x32_bf16 v[8:11], v[72:75], a[64:67], v[8:11]
    ds_read_b64_tr_b16 v[92:93], v6 offset:13824
    v_mfma_f32_16x16x32_bf16 v[12:15], v[72:75], a[68:71], v[12:15]
    ds_read_b64_tr_b16 v[94:95], v6 offset:13968
    s_waitcnt lgkmcnt(8)
    v_mfma_f32_16x16x32_bf16 v[16:19], v[76:79], a[64:67], v[16:19]
    ds_read_b64_tr_b16 v[96:97], v6 offset:13856
    buffer_load_dwordx4 a[120:123], v105, s[16:19], s51 offen offset:1024 sc1
    v_mfma_f32_16x16x32_bf16 v[20:23], v[76:79], a[68:71], v[20:23]
    ds_read_b64_tr_b16 v[98:99], v6 offset:14000
    s_waitcnt lgkmcnt(8)
    v_mfma_f32_16x16x32_bf16 v[24:27], v[80:83], a[64:67], v[24:27]
    ds_read_b64_tr_b16 v[100:101], v6 offset:13888
    v_mfma_f32_16x16x32_bf16 v[28:31], v[80:83], a[68:71], v[28:31]
    ds_read_b64_tr_b16 v[102:103], v6 offset:14032
    s_waitcnt lgkmcnt(8)
    v_mfma_f32_16x16x32_bf16 v[32:35], v[84:87], a[64:67], v[32:35]
    ds_read_b64_tr_b16 v[72:73], v6 offset:13920
    buffer_load_dwordx4 a[124:127], v106, s[16:19], s51 offen offset:1024 sc1
    v_mfma_f32_16x16x32_bf16 v[36:39], v[84:87], a[68:71], v[36:39]
    ds_read_b64_tr_b16 v[74:75], v6 offset:14064
    s_waitcnt lgkmcnt(8)
    v_mfma_f32_16x16x32_bf16 v[40:43], v[88:91], a[64:67], v[40:43]
    ds_read_b64_tr_b16 v[76:77], v6 offset:13952
    v_mfma_f32_16x16x32_bf16 v[44:47], v[88:91], a[68:71], v[44:47]
    ds_read_b64_tr_b16 v[78:79], v6 offset:14096
    s_waitcnt vmcnt(12) lgkmcnt(8)
    v_mfma_f32_16x16x32_bf16 v[8:11], v[92:95], a[72:75], v[8:11]
    ds_read_b64_tr_b16 v[80:81], v6 offset:18432
    v_mfma_f32_16x16x32_bf16 v[12:15], v[92:95], a[76:79], v[12:15]
    ds_read_b64_tr_b16 v[82:83], v6 offset:18576
    s_waitcnt lgkmcnt(8)
    v_mfma_f32_16x16x32_bf16 v[16:19], v[96:99], a[72:75], v[16:19]
    ds_read_b64_tr_b16 v[84:85], v6 offset:18464
    buffer_load_dwordx4 a[128:131], v105, s[16:19], s23 offen sc1
    v_mfma_f32_16x16x32_bf16 v[20:23], v[96:99], a[76:79], v[20:23]
    ds_read_b64_tr_b16 v[86:87], v6 offset:18608
    s_waitcnt lgkmcnt(8)
    v_mfma_f32_16x16x32_bf16 v[24:27], v[100:103], a[72:75], v[24:27]
    ds_read_b64_tr_b16 v[88:89], v6 offset:18496
    v_mfma_f32_16x16x32_bf16 v[28:31], v[100:103], a[76:79], v[28:31]
    ds_read_b64_tr_b16 v[90:91], v6 offset:18640
    s_waitcnt lgkmcnt(8)
    v_mfma_f32_16x16x32_bf16 v[32:35], v[72:75], a[72:75], v[32:35]
    ds_read_b64_tr_b16 v[92:93], v6 offset:18528
    buffer_load_dwordx4 a[132:135], v106, s[16:19], s23 offen sc1
    v_mfma_f32_16x16x32_bf16 v[36:39], v[72:75], a[76:79], v[36:39]
    ds_read_b64_tr_b16 v[94:95], v6 offset:18672
    s_waitcnt lgkmcnt(8)
    v_mfma_f32_16x16x32_bf16 v[40:43], v[76:79], a[72:75], v[40:43]
    ds_read_b64_tr_b16 v[96:97], v6 offset:18560
    v_mfma_f32_16x16x32_bf16 v[44:47], v[76:79], a[76:79], v[44:47]
    ds_read_b64_tr_b16 v[98:99], v6 offset:18704
    s_waitcnt vmcnt(12) lgkmcnt(8)
    v_mfma_f32_16x16x32_bf16 v[8:11], v[80:83], a[80:83], v[8:11]
    ds_read_b64_tr_b16 v[100:101], v6 offset:23040
    v_mfma_f32_16x16x32_bf16 v[12:15], v[80:83], a[84:87], v[12:15]
    ds_read_b64_tr_b16 v[102:103], v6 offset:23184
    s_waitcnt lgkmcnt(8)
    v_mfma_f32_16x16x32_bf16 v[16:19], v[84:87], a[80:83], v[16:19]
    ds_read_b64_tr_b16 v[72:73], v6 offset:23072
    buffer_load_dwordx4 a[136:139], v105, s[16:19], s23 offen offset:1024 sc1
    v_mfma_f32_16x16x32_bf16 v[20:23], v[84:87], a[84:87], v[20:23]
    ds_read_b64_tr_b16 v[74:75], v6 offset:23216
    s_waitcnt lgkmcnt(8)
    v_mfma_f32_16x16x32_bf16 v[24:27], v[88:91], a[80:83], v[24:27]
    ds_read_b64_tr_b16 v[76:77], v6 offset:23104
    v_mfma_f32_16x16x32_bf16 v[28:31], v[88:91], a[84:87], v[28:31]
    ds_read_b64_tr_b16 v[78:79], v6 offset:23248
    s_waitcnt lgkmcnt(8)
    v_mfma_f32_16x16x32_bf16 v[32:35], v[92:95], a[80:83], v[32:35]
    ds_read_b64_tr_b16 v[80:81], v6 offset:23136
    buffer_load_dwordx4 a[140:143], v106, s[16:19], s23 offen offset:1024 sc1
    v_mfma_f32_16x16x32_bf16 v[36:39], v[92:95], a[84:87], v[36:39]
    ds_read_b64_tr_b16 v[82:83], v6 offset:23280
    s_waitcnt lgkmcnt(8)
    v_mfma_f32_16x16x32_bf16 v[40:43], v[96:99], a[80:83], v[40:43]
    ds_read_b64_tr_b16 v[84:85], v6 offset:23168
    v_mfma_f32_16x16x32_bf16 v[44:47], v[96:99], a[84:87], v[44:47]
    ds_read_b64_tr_b16 v[86:87], v6 offset:23312
    s_waitcnt vmcnt(12) lgkmcnt(8)
    v_mfma_f32_16x16x32_bf16 v[8:11], v[100:103], a[88:91], v[8:11]
    ds_read_b64_tr_b16 v[88:89], v6 offset:27648
    v_mfma_f32_16x16x32_bf16 v[12:15], v[100:103], a[92:95], v[12:15]
    ds_read_b64_tr_b16 v[90:91], v6 offset:27792
    s_waitcnt lgkmcnt(8)
    v_mfma_f32_16x16x32_bf16 v[16:19], v[72:75], a[88:91], v[16:19]
    ds_read_b64_tr_b16 v[92:93], v6 offset:27680
    v_mfma_f32_16x16x32_bf16 v[20:23], v[72:75], a[92:95], v[20:23]
    ds_read_b64_tr_b16 v[94:95], v6 offset:27824
    s_waitcnt lgkmcnt(8)
    v_mfma_f32_16x16x32_bf16 v[24:27], v[76:79], a[88:91], v[24:27]
    ds_read_b64_tr_b16 v[96:97], v6 offset:27712
    v_mfma_f32_16x16x32_bf16 v[28:31], v[76:79], a[92:95], v[28:31]
    ds_read_b64_tr_b16 v[98:99], v6 offset:27856
    s_waitcnt lgkmcnt(8)
    v_mfma_f32_16x16x32_bf16 v[32:35], v[80:83], a[88:91], v[32:35]
    ds_read_b64_tr_b16 v[100:101], v6 offset:27744
    v_mfma_f32_16x16x32_bf16 v[36:39], v[80:83], a[92:95], v[36:39]
    ds_read_b64_tr_b16 v[102:103], v6 offset:27888
    s_waitcnt lgkmcnt(8)
    v_mfma_f32_16x16x32_bf16 v[40:43], v[84:87], a[88:91], v[40:43]
    ds_read_b64_tr_b16 v[72:73], v6 offset:27776
    v_mfma_f32_16x16x32_bf16 v[44:47], v[84:87], a[92:95], v[44:47]
    ds_read_b64_tr_b16 v[74:75], v6 offset:27920
    s_waitcnt vmcnt(10) lgkmcnt(8)
    v_mfma_f32_16x16x32_bf16 v[8:11], v[88:91], a[96:99], v[8:11]
    ds_read_b64_tr_b16 v[76:77], v7 offset:34816
    v_mfma_f32_16x16x32_bf16 v[12:15], v[88:91], a[100:103], v[12:15]
    ds_read_b64_tr_b16 v[78:79], v7 offset:34960
    s_waitcnt lgkmcnt(8)
    v_mfma_f32_16x16x32_bf16 v[16:19], v[92:95], a[96:99], v[16:19]
    ds_read_b64_tr_b16 v[80:81], v7 offset:34848
    v_mfma_f32_16x16x32_bf16 v[20:23], v[92:95], a[100:103], v[20:23]
    ds_read_b64_tr_b16 v[82:83], v7 offset:34992
    s_waitcnt lgkmcnt(8)
    v_mfma_f32_16x16x32_bf16 v[24:27], v[96:99], a[96:99], v[24:27]
    ds_read_b64_tr_b16 v[84:85], v7 offset:34880
    v_mfma_f32_16x16x32_bf16 v[28:31], v[96:99], a[100:103], v[28:31]
    ds_read_b64_tr_b16 v[86:87], v7 offset:35024
    s_waitcnt lgkmcnt(8)
    v_mfma_f32_16x16x32_bf16 v[32:35], v[100:103], a[96:99], v[32:35]
    ds_read_b64_tr_b16 v[88:89], v7 offset:34912
    v_mfma_f32_16x16x32_bf16 v[36:39], v[100:103], a[100:103], v[36:39]
    ds_read_b64_tr_b16 v[90:91], v7 offset:35056
    s_waitcnt lgkmcnt(8)
    v_mfma_f32_16x16x32_bf16 v[40:43], v[72:75], a[96:99], v[40:43]
    ds_read_b64_tr_b16 v[92:93], v7 offset:34944
    v_mfma_f32_16x16x32_bf16 v[44:47], v[72:75], a[100:103], v[44:47]
    ds_read_b64_tr_b16 v[94:95], v7 offset:35088
    s_waitcnt vmcnt(8) lgkmcnt(8)
    v_mfma_f32_16x16x32_bf16 v[8:11], v[76:79], a[104:107], v[8:11]
    ds_read_b64_tr_b16 v[96:97], v7 offset:39424
    v_mfma_f32_16x16x32_bf16 v[12:15], v[76:79], a[108:111], v[12:15]
    ds_read_b64_tr_b16 v[98:99], v7 offset:39568
    s_waitcnt lgkmcnt(8)
    v_mfma_f32_16x16x32_bf16 v[16:19], v[80:83], a[104:107], v[16:19]
    ds_read_b64_tr_b16 v[100:101], v7 offset:39456
    v_mfma_f32_16x16x32_bf16 v[20:23], v[80:83], a[108:111], v[20:23]
    ds_read_b64_tr_b16 v[102:103], v7 offset:39600
    s_waitcnt lgkmcnt(8)
    v_mfma_f32_16x16x32_bf16 v[24:27], v[84:87], a[104:107], v[24:27]
    ds_read_b64_tr_b16 v[72:73], v7 offset:39488
    v_mfma_f32_16x16x32_bf16 v[28:31], v[84:87], a[108:111], v[28:31]
    ds_read_b64_tr_b16 v[74:75], v7 offset:39632
    s_waitcnt lgkmcnt(8)
    v_mfma_f32_16x16x32_bf16 v[32:35], v[88:91], a[104:107], v[32:35]
    ds_read_b64_tr_b16 v[76:77], v7 offset:39520
    v_mfma_f32_16x16x32_bf16 v[36:39], v[88:91], a[108:111], v[36:39]
    ds_read_b64_tr_b16 v[78:79], v7 offset:39664
    s_waitcnt lgkmcnt(8)
    v_mfma_f32_16x16x32_bf16 v[40:43], v[92:95], a[104:107], v[40:43]
    ds_read_b64_tr_b16 v[80:81], v7 offset:39552
    v_mfma_f32_16x16x32_bf16 v[44:47], v[92:95], a[108:111], v[44:47]
    ds_read_b64_tr_b16 v[82:83], v7 offset:39696
    s_waitcnt vmcnt(6) lgkmcnt(8)
    v_mfma_f32_16x16x32_bf16 v[8:11], v[96:99], a[112:115], v[8:11]
    ds_read_b64_tr_b16 v[84:85], v7 offset:44032
    v_mfma_f32_16x16x32_bf16 v[12:15], v[96:99], a[116:119], v[12:15]
    ds_read_b64_tr_b16 v[86:87], v7 offset:44176
    s_waitcnt lgkmcnt(8)
    v_mfma_f32_16x16x32_bf16 v[16:19], v[100:103], a[112:115], v[16:19]
    ds_read_b64_tr_b16 v[88:89], v7 offset:44064
    v_mfma_f32_16x16x32_bf16 v[20:23], v[100:103], a[116:119], v[20:23]
    ds_read_b64_tr_b16 v[90:91], v7 offset:44208
    s_waitcnt lgkmcnt(8)
    v_mfma_f32_16x16x32_bf16 v[24:27], v[72:75], a[112:115], v[24:27]
    ds_read_b64_tr_b16 v[92:93], v7 offset:44096
    v_mfma_f32_16x16x32_bf16 v[28:31], v[72:75], a[116:119], v[28:31]
    ds_read_b64_tr_b16 v[94:95], v7 offset:44240
    s_waitcnt lgkmcnt(8)
    v_mfma_f32_16x16x32_bf16 v[32:35], v[76:79], a[112:115], v[32:35]
    ds_read_b64_tr_b16 v[96:97], v7 offset:44128
    v_mfma_f32_16x16x32_bf16 v[36:39], v[76:79], a[116:119], v[36:39]
    ds_read_b64_tr_b16 v[98:99], v7 offset:44272
    s_waitcnt lgkmcnt(8)
    v_mfma_f32_16x16x32_bf16 v[40:43], v[80:83], a[112:115], v[40:43]
    ds_read_b64_tr_b16 v[100:101], v7 offset:44160
    v_mfma_f32_16x16x32_bf16 v[44:47], v[80:83], a[116:119], v[44:47]
    ds_read_b64_tr_b16 v[102:103], v7 offset:44304
    s_waitcnt vmcnt(4) lgkmcnt(8)
    v_mfma_f32_16x16x32_bf16 v[8:11], v[84:87], a[120:123], v[8:11]
    ds_read_b64_tr_b16 v[72:73], v7 offset:48640
    v_mfma_f32_16x16x32_bf16 v[12:15], v[84:87], a[124:127], v[12:15]
    ds_read_b64_tr_b16 v[74:75], v7 offset:48784
    s_waitcnt lgkmcnt(8)
    v_mfma_f32_16x16x32_bf16 v[16:19], v[88:91], a[120:123], v[16:19]
    ds_read_b64_tr_b16 v[76:77], v7 offset:48672
    v_mfma_f32_16x16x32_bf16 v[20:23], v[88:91], a[124:127], v[20:23]
    ds_read_b64_tr_b16 v[78:79], v7 offset:48816
    s_waitcnt lgkmcnt(8)
    v_mfma_f32_16x16x32_bf16 v[24:27], v[92:95], a[120:123], v[24:27]
    ds_read_b64_tr_b16 v[80:81], v7 offset:48704
    v_mfma_f32_16x16x32_bf16 v[28:31], v[92:95], a[124:127], v[28:31]
    ds_read_b64_tr_b16 v[82:83], v7 offset:48848
    s_waitcnt lgkmcnt(8)
    v_mfma_f32_16x16x32_bf16 v[32:35], v[96:99], a[120:123], v[32:35]
    ds_read_b64_tr_b16 v[84:85], v7 offset:48736
    v_mfma_f32_16x16x32_bf16 v[36:39], v[96:99], a[124:127], v[36:39]
    ds_read_b64_tr_b16 v[86:87], v7 offset:48880
    s_waitcnt lgkmcnt(8)
    v_mfma_f32_16x16x32_bf16 v[40:43], v[100:103], a[120:123], v[40:43]
    ds_read_b64_tr_b16 v[88:89], v7 offset:48768
    v_mfma_f32_16x16x32_bf16 v[44:47], v[100:103], a[124:127], v[44:47]
    ds_read_b64_tr_b16 v[90:91], v7 offset:48912
    s_waitcnt vmcnt(2) lgkmcnt(8)
    v_mfma_f32_16x16x32_bf16 v[8:11], v[72:75], a[128:131], v[8:11]
    ds_read_b64_tr_b16 v[92:93], v7 offset:53248
    v_mfma_f32_16x16x32_bf16 v[12:15], v[72:75], a[132:135], v[12:15]
    ds_read_b64_tr_b16 v[94:95], v7 offset:53392
    s_waitcnt lgkmcnt(8)
    v_mfma_f32_16x16x32_bf16 v[16:19], v[76:79], a[128:131], v[16:19]
    ds_read_b64_tr_b16 v[96:97], v7 offset:53280
    v_mfma_f32_16x16x32_bf16 v[20:23], v[76:79], a[132:135], v[20:23]
    ds_read_b64_tr_b16 v[98:99], v7 offset:53424
    s_waitcnt lgkmcnt(8)
    v_mfma_f32_16x16x32_bf16 v[24:27], v[80:83], a[128:131], v[24:27]
    ds_read_b64_tr_b16 v[100:101], v7 offset:53312
    v_mfma_f32_16x16x32_bf16 v[28:31], v[80:83], a[132:135], v[28:31]
    ds_read_b64_tr_b16 v[102:103], v7 offset:53456
    s_waitcnt lgkmcnt(8)
    v_mfma_f32_16x16x32_bf16 v[32:35], v[84:87], a[128:131], v[32:35]
    ds_read_b64_tr_b16 v[72:73], v7 offset:53344
    v_mfma_f32_16x16x32_bf16 v[36:39], v[84:87], a[132:135], v[36:39]
    ds_read_b64_tr_b16 v[74:75], v7 offset:53488
    s_waitcnt lgkmcnt(8)
    v_mfma_f32_16x16x32_bf16 v[40:43], v[88:91], a[128:131], v[40:43]
    ds_read_b64_tr_b16 v[76:77], v7 offset:53376
    v_mfma_f32_16x16x32_bf16 v[44:47], v[88:91], a[132:135], v[44:47]
    ds_read_b64_tr_b16 v[78:79], v7 offset:53520
    s_waitcnt vmcnt(0) lgkmcnt(8)
    v_mfma_f32_16x16x32_bf16 v[8:11], v[92:95], a[136:139], v[8:11]
    v_mfma_f32_16x16x32_bf16 v[12:15], v[92:95], a[140:143], v[12:15]
    s_waitcnt lgkmcnt(6)
    v_mfma_f32_16x16x32_bf16 v[16:19], v[96:99], a[136:139], v[16:19]
    v_mfma_f32_16x16x32_bf16 v[20:23], v[96:99], a[140:143], v[20:23]
    s_waitcnt lgkmcnt(4)
    v_mfma_f32_16x16x32_bf16 v[24:27], v[100:103], a[136:139], v[24:27]
    s_nop 1
    v_cvt_pk_bf16_f32 v48, v8, v9
    v_cvt_pk_bf16_f32 v49, v10, v11
    v_mfma_f32_16x16x32_bf16 v[28:31], v[100:103], a[140:143], v[28:31]
    ds_write_b64 v4, v[48:49] offset:0
    v_cvt_pk_bf16_f32 v50, v12, v13
    s_waitcnt lgkmcnt(3)
    v_mfma_f32_16x16x32_bf16 v[32:35], v[72:75], a[136:139], v[32:35]
    v_cvt_pk_bf16_f32 v51, v14, v15
    ds_write_b64 v4, v[50:51] offset:2304
    v_mfma_f32_16x16x32_bf16 v[36:39], v[72:75], a[140:143], v[36:39]
    v_cvt_pk_bf16_f32 v52, v16, v17
    v_cvt_pk_bf16_f32 v53, v18, v19
    s_waitcnt lgkmcnt(2)
    v_mfma_f32_16x16x32_bf16 v[40:43], v[76:79], a[136:139], v[40:43]
    ds_write_b64 v4, v[52:53] offset:32
    v_cvt_pk_bf16_f32 v54, v20, v21
    v_mfma_f32_16x16x32_bf16 v[44:47], v[76:79], a[140:143], v[44:47]
    v_cvt_pk_bf16_f32 v55, v22, v23
    ds_write_b64 v4, v[54:55] offset:2336
    v_cvt_pk_bf16_f32 v56, v24, v25
    v_cvt_pk_bf16_f32 v57, v26, v27
    ds_write_b64 v4, v[56:57] offset:64
    v_cvt_pk_bf16_f32 v58, v28, v29
    v_cvt_pk_bf16_f32 v59, v30, v31
    ds_write_b64 v4, v[58:59] offset:2368
    v_cvt_pk_bf16_f32 v60, v32, v33
    v_cvt_pk_bf16_f32 v61, v34, v35
    ds_write_b64 v4, v[60:61] offset:96
    v_cvt_pk_bf16_f32 v62, v36, v37
    v_cvt_pk_bf16_f32 v63, v38, v39
    ds_write_b64 v4, v[62:63] offset:2400
    s_cmp_lg_u32 s39, 0
    s_cbranch_scc1 L_b_store
    v_cmp_u_f32 vcc, v8, v12
    s_nop 0
    s_cbranch_vccnz L_b_strict
L_b_store:
    s_mov_b32 exec_hi, 0
    v_cvt_pk_bf16_f32 v64, v40, v41
    v_cvt_pk_bf16_f32 v65, v42, v43
    ds_write_b64 v4, v[64:65] offset:128
    v_cvt_pk_bf16_f32 v66, v44, v45
    v_cvt_pk_bf16_f32 v67, v46, v47
    ds_write_b64 v4, v[66:67] offset:2432
    s_mov_b32 exec_hi, -1
    ds_read_b128 v[8:11], v5 offset:0
    ds_read_b128 v[12:15], v5 offset:1024
    ds_read_b128 v[16:19], v5 offset:2048
    ds_read_b128 v[20:23], v5 offset:3072
    ds_read_b128 v[24:27], v5 offset:4096
    s_waitcnt lgkmcnt(4)
    global_store_dwordx4 v108, v[8:11], s[10:11]
    s_waitcnt lgkmcnt(3)
    global_store_dwordx4 v109, v[12:15], s[10:11]
    s_waitcnt lgkmcnt(2)
    global_store_dwordx4 v110, v[16:19], s[10:11]
    s_waitcnt lgkmcnt(1)
    global_store_dwordx4 v111, v[20:23], s[10:11]
    s_waitcnt lgkmcnt(0)
    s_mov_b32 exec_hi, 0
    global_store_dwordx4 v104, v[24:27], s[10:11]
    s_mov_b32 exec_hi, -1
    s_endpgm
L_b_strict:
    s_mov_b32 s39, 1
    s_mov_b32 s44, 20000
L_b_strict1:
    s_movk_i32 s22, 0
    buffer_load_dwordx4 a[0:3], v105, s[16:19], s22 offen sc1
    buffer_load_dwordx4 a[4:7], v106, s[16:19], s22 offen sc1
    s_movk_i32 s22, 1024
    buffer_load_dwordx4 a[8:11], v105, s[16:19], s22 offen sc1
    buffer_load_dwordx4 a[12:15], v106, s[16:19], s22 offen sc1
    s_movk_i32 s22, 2048
    buffer_load_dwordx4 a[16:19], v105, s[16:19], s22 offen sc1
    buffer_load_dwordx4 a[20:23], v106, s[16:19], s22 offen sc1
    s_movk_i32 s22, 3072
    buffer_load_dwordx4 a[24:27], v105, s[16:19], s22 offen sc1
    buffer_load_dwordx4 a[28:31], v106, s[16:19], s22 offen sc1
    s_movk_i32 s22, 4096
    buffer_load_dwordx4 a[32:35], v105, s[16:19], s22 offen sc1
    buffer_load_dwordx4 a[36:39], v106, s[16:19], s22 offen sc1
    s_movk_i32 s22, 5120
    buffer_load_dwordx4 a[40:43], v105, s[16:19], s22 offen sc1
    buffer_load_dwordx4 a[44:47], v106, s[16:19], s22 offen sc1
    s_movk_i32 s22, 6144
    buffer_load_dwordx4 a[48:51], v105, s[16:19], s22 offen sc1
    buffer_load_dwordx4 a[52:55], v106, s[16:19], s22 offen sc1
    s_movk_i32 s22, 7168
    buffer_load_dwordx4 a[56:59], v105, s[16:19], s22 offen sc1
    buffer_load_dwordx4 a[60:63], v106, s[16:19], s22 offen sc1
    s_movk_i32 s22, 8192
    buffer_load_dwordx4 a[64:67], v105, s[16:19], s22 offen sc1
    buffer_load_dwordx4 a[68:71], v106, s[16:19], s22 offen sc1
    s_movk_i32 s22, 9216
    buffer_load_dwordx4 a[72:75], v105, s[16:19], s22 offen sc1
    buffer_load_dwordx4 a[76:79], v106, s[16:19], s22 offen sc1
    s_movk_i32 s22, 10240
    buffer_load_dwordx4 a[80:83], v105, s[16:19], s22 offen sc1
    buffer_load_dwordx4 a[84:87], v106, s[16:19], s22 offen sc1
    s_movk_i32 s22, 11264
    buffer_load_dwordx4 a[88:91], v105, s[16:19], s22 offen sc1
    buffer_load_dwordx4 a[92:95], v106, s[16:19], s22 offen sc1
    s_movk_i32 s22, 12288
    buffer_load_dwordx4 a[96:99], v105, s[16:19], s22 offen sc1
    buffer_load_dwordx4 a[100:103], v106, s[16:19], s22 offen sc1
    s_movk_i32 s22, 13312
    buffer_load_dwordx4 a[104:107], v105, s[16:19], s22 offen sc1
    buffer_load_dwordx4 a[108:111], v106, s[16:19], s22 offen sc1
    s_movk_i32 s22, 14336
    buffer_load_dwordx4 a[112:115], v105, s[16:19], s22 offen sc1
    buffer_load_dwordx4 a[116:119], v106, s[16:19], s22 offen sc1
    s_movk_i32 s22, 15360
    buffer_load_dwordx4 a[120:123], v105, s[16:19], s22 offen sc1
    buffer_load_dwordx4 a[124:127], v106, s[16:19], s22 offen sc1
    s_movk_i32 s22, 16384
    buffer_load_dwordx4 a[128:131], v105, s[16:19], s22 offen sc1
    buffer_load_dwordx4 a[132:135], v106, s[16:19], s22 offen sc1
    s_movk_i32 s22, 17408
    buffer_load_dwordx4 a[136:139], v105, s[16:19], s22 offen sc1
    buffer_load_dwordx4 a[140:143], v106, s[16:19], s22 offen sc1
    buffer_load_dwordx4 v[48:51], v105, s[16:19], s20 offen offset:0 sc1
    buffer_load_dwordx4 v[52:55], v105, s[16:19], s20 offen offset:1024 sc1
    buffer_load_dwordx4 v[58:61], v106, s[16:19], s20 offen offset:0 sc1
    buffer_load_dwordx4 v[62:65], v106, s[16:19], s20 offen offset:1024 sc1
    s_waitcnt vmcnt(0)
    s_sub_u32 s44, s44, 1
    s_cbranch_scc1 L_b_gemm2
    s_mov_b64 s[32:33], 0
    v_accvgpr_read_b32 v68, a0
    v_cmp_eq_u32 vcc, -1, v68
    s_nop 0
    s_or_b64 s[32:33], s[32:33], vcc
    v_accvgpr_read_b32 v68, a4
    v_cmp_eq_u32 vcc, -1, v68
    s_nop 0
    s_or_b64 s[32:33], s[32:33], vcc
    v_accvgpr_read_b32 v68, a8
    v_cmp_eq_u32 vcc, -1, v68
    s_nop 0
    s_or_b64 s[32:33], s[32:33], vcc
    v_accvgpr_read_b32 v68, a12
    v_cmp_eq_u32 vcc, -1, v68
    s_nop 0
    s_or_b64 s[32:33], s[32:33], vcc
    v_accvgpr_read_b32 v68, a16
    v_cmp_eq_u32 vcc, -1, v68
    s_nop 0
    s_or_b64 s[32:33], s[32:33], vcc
    v_accvgpr_read_b32 v68, a20
    v_cmp_eq_u32 vcc, -1, v68
    s_nop 0
    s_or_b64 s[32:33], s[32:33], vcc
    v_accvgpr_read_b32 v68, a24
    v_cmp_eq_u32 vcc, -1, v68
    s_nop 0
    s_or_b64 s[32:33], s[32:33], vcc
    v_accvgpr_read_b32 v68, a28
    v_cmp_eq_u32 vcc, -1, v68
    s_nop 0
    s_or_b64 s[32:33], s[32:33], vcc
    v_accvgpr_read_b32 v68, a32
    v_cmp_eq_u32 vcc, -1, v68
    s_nop 0
    s_or_b64 s[32:33], s[32:33], vcc
    v_accvgpr_read_b32 v68, a36
    v_cmp_eq_u32 vcc, -1, v68
    s_nop 0
    s_or_b64 s[32:33], s[32:33], vcc
    v_accvgpr_read_b32 v68, a40
    v_cmp_eq_u32 vcc, -1, v68
    s_nop 0
    s_or_b64 s[32:33], s[32:33], vcc
    v_accvgpr_read_b32 v68, a44
    v_cmp_eq_u32 vcc, -1, v68
    s_nop 0
    s_or_b64 s[32:33], s[32:33], vcc
    v_accvgpr_read_b32 v68, a48
    v_cmp_eq_u32 vcc, -1, v68
    s_nop 0
    s_or_b64 s[32:33], s[32:33], vcc
    v_accvgpr_read_b32 v68, a52
    v_cmp_eq_u32 vcc, -1, v68
    s_nop 0
    s_or_b64 s[32:33], s[32:33], vcc
    v_accvgpr_read_b32 v68, a56
    v_cmp_eq_u32 vcc, -1, v68
    s_nop 0
    s_or_b64 s[32:33], s[32:33], vcc
    v_accvgpr_read_b32 v68, a60
    v_cmp_eq_u32 vcc, -1, v68
    s_nop 0
    s_or_b64 s[32:33], s[32:33], vcc
    v_accvgpr_read_b32 v68, a64
    v_cmp_eq_u32 vcc, -1, v68
    s_nop 0
    s_or_b64 s[32:33], s[32:33], vcc
    v_accvgpr_read_b32 v68, a68
    v_cmp_eq_u32 vcc, -1, v68
    s_nop 0
    s_or_b64 s[32:33], s[32:33], vcc
    v_accvgpr_read_b32 v68, a72
    v_cmp_eq_u32 vcc, -1, v68
    s_nop 0
    s_or_b64 s[32:33], s[32:33], vcc
    v_accvgpr_read_b32 v68, a76
    v_cmp_eq_u32 vcc, -1, v68
    s_nop 0
    s_or_b64 s[32:33], s[32:33], vcc
    v_accvgpr_read_b32 v68, a80
    v_cmp_eq_u32 vcc, -1, v68
    s_nop 0
    s_or_b64 s[32:33], s[32:33], vcc
    v_accvgpr_read_b32 v68, a84
    v_cmp_eq_u32 vcc, -1, v68
    s_nop 0
    s_or_b64 s[32:33], s[32:33], vcc
    v_accvgpr_read_b32 v68, a88
    v_cmp_eq_u32 vcc, -1, v68
    s_nop 0
    s_or_b64 s[32:33], s[32:33], vcc
    v_accvgpr_read_b32 v68, a92
    v_cmp_eq_u32 vcc, -1, v68
    s_nop 0
    s_or_b64 s[32:33], s[32:33], vcc
    v_accvgpr_read_b32 v68, a96
    v_cmp_eq_u32 vcc, -1, v68
    s_nop 0
    s_or_b64 s[32:33], s[32:33], vcc
    v_accvgpr_read_b32 v68, a100
    v_cmp_eq_u32 vcc, -1, v68
    s_nop 0
    s_or_b64 s[32:33], s[32:33], vcc
    v_accvgpr_read_b32 v68, a104
    v_cmp_eq_u32 vcc, -1, v68
    s_nop 0
    s_or_b64 s[32:33], s[32:33], vcc
    v_accvgpr_read_b32 v68, a108
    v_cmp_eq_u32 vcc, -1, v68
    s_nop 0
    s_or_b64 s[32:33], s[32:33], vcc
    v_accvgpr_read_b32 v68, a112
    v_cmp_eq_u32 vcc, -1, v68
    s_nop 0
    s_or_b64 s[32:33], s[32:33], vcc
    v_accvgpr_read_b32 v68, a116
    v_cmp_eq_u32 vcc, -1, v68
    s_nop 0
    s_or_b64 s[32:33], s[32:33], vcc
    v_accvgpr_read_b32 v68, a120
    v_cmp_eq_u32 vcc, -1, v68
    s_nop 0
    s_or_b64 s[32:33], s[32:33], vcc
    v_accvgpr_read_b32 v68, a124
    v_cmp_eq_u32 vcc, -1, v68
    s_nop 0
    s_or_b64 s[32:33], s[32:33], vcc
    v_accvgpr_read_b32 v68, a128
    v_cmp_eq_u32 vcc, -1, v68
    s_nop 0
    s_or_b64 s[32:33], s[32:33], vcc
    v_accvgpr_read_b32 v68, a130
    v_cmp_eq_u32 vcc, -1, v68
    s_nop 0
    s_or_b64 s[32:33], s[32:33], vcc
    v_accvgpr_read_b32 v68, a132
    v_cmp_eq_u32 vcc, -1, v68
    s_nop 0
    s_or_b64 s[32:33], s[32:33], vcc
    v_accvgpr_read_b32 v68, a134
    v_cmp_eq_u32 vcc, -1, v68
    s_nop 0
    s_or_b64 s[32:33], s[32:33], vcc
    v_accvgpr_read_b32 v68, a136
    v_cmp_eq_u32 vcc, -1, v68
    s_nop 0
    s_or_b64 s[32:33], s[32:33], vcc
    v_accvgpr_read_b32 v68, a138
    v_cmp_eq_u32 vcc, -1, v68
    s_nop 0
    s_or_b64 s[32:33], s[32:33], vcc
    v_accvgpr_read_b32 v68, a140
    v_cmp_eq_u32 vcc, -1, v68
    s_nop 0
    s_or_b64 s[32:33], s[32:33], vcc
    v_accvgpr_read_b32 v68, a142
    v_cmp_eq_u32 vcc, -1, v68
    s_nop 0
    s_or_b64 s[32:33], s[32:33], vcc
    s_cmp_lg_u64 s[32:33], 0
    s_cbranch_scc1 L_b_strict1
    s_branch L_b_gemm2
L_end:
.section .rodata,"a"
.p2align 6
.amdhsa_kernel concat_heads__ssm_conv_s4__linear_attn_block__prompt_kernel
  .amdhsa_next_free_vgpr 256
  .amdhsa_next_free_sgpr 102
  .amdhsa_accum_offset 112
  .amdhsa_group_segment_fixed_size 0
  .amdhsa_kernarg_size 120
  .amdhsa_user_sgpr_count 2
  .amdhsa_user_sgpr_kernarg_segment_ptr 1
  .amdhsa_system_sgpr_workgroup_id_x 1
.end_amdhsa_kernel
```
